```python
import torch

def _softmax(x, axis=-1):
    return torch.softmax(x, dim=axis)
def _gelu(x):
    return torch.nn.functional.gelu(x, approximate="tanh")
def _silu(x):
    return torch.nn.functional.silu(x)
def _sigmoid(x):
    return torch.sigmoid(x)
def _layernorm(x, axis=-1, eps=1e-5):
    m = x.mean(dim=axis, keepdim=True)
    v = x.var(dim=axis, keepdim=True, unbiased=False)
    return (x - m) / torch.sqrt(v + eps)
def _scatter_add(tgt, idx, src, axis=0):
    return tgt.clone().index_add_(axis, idx, src)
def _segment_sum(src, seg, n):
    out = torch.zeros((n,) + src.shape[1:], dtype=src.dtype)
    return out.index_add_(0, seg, src)
def _pad(x, pw):
    flat = tuple(v for pair in reversed(pw) for v in pair)
    return torch.nn.functional.pad(x, flat)

kernel_name = 'gated_mix__sliding_block_cached__dense_activation_gelu__decode'

def setup_inputs():

    _w = (lambda a: (lambda t: t.to(torch.bfloat16) if t.is_floating_point() else t)(torch.as_tensor(a)))
    def _A_setup():
        B, Sq, D = 2, 1, 512
        Hq, Hkv, Sk, Dh = 32, 8, 8192, 128
        assert Hq % Hkv == 0, (Hq, Hkv)
        return {
            "x": _w((lambda *s: torch.randn(*s, dtype=torch.bfloat16) * 0.05)(B, Sq, D)),
            "k_cache": _w((lambda *s: torch.randn(*s, dtype=torch.bfloat16) * 6.4)(B, Hkv, Sk, Dh)),
            "v_cache": _w((lambda *s: torch.randn(*s, dtype=torch.bfloat16) * 0.4)(B, Hkv, Sk, Dh)),
            "wq": _w((lambda *s: torch.randn(*s, dtype=torch.bfloat16) * 6.4)(D, Hq * Dh) * (D ** -0.5)),
            "wo": _w((lambda *s: torch.randn(*s, dtype=torch.bfloat16) * 0.4)(Hq * Dh, D) * ((Hq * Dh) ** -0.5)),
        }
    _A_in = _A_setup()

    def _B_setup():
        B, S, D, F = 2, 1, 512, 1792
        return {
            "x": _w((lambda *s: torch.randn(*s, dtype=torch.bfloat16) * 0.05)(B, S, D)),
            "w1": _w((lambda *s: torch.randn(*s, dtype=torch.bfloat16) * 3.2)(D, F) * (D ** -0.5)),
            "b1": _w((lambda *s: torch.randn(*s, dtype=torch.bfloat16) * 3.2)(F) * 0.01),
            "w2": _w((lambda *s: torch.randn(*s, dtype=torch.bfloat16) * 0.4)(F, D) * (F ** -0.5)),
            "b2": _w((lambda *s: torch.randn(*s, dtype=torch.bfloat16) * 0.8)(D) * 0.01),
        }
    _B_in = _B_setup()

    return {
        "A_x": _A_in["x"],
        "A_k_cache": _A_in["k_cache"],
        "A_v_cache": _A_in["v_cache"],
        "A_wq": _A_in["wq"],
        "A_wo": _A_in["wo"],
        "B_x": _B_in["x"],
        "B_w1": _B_in["w1"],
        "B_b1": _B_in["b1"],
        "B_w2": _B_in["w2"],
        "B_b2": _B_in["b2"],
        "gate_w": _w((lambda *s: torch.randn(*s, dtype=torch.bfloat16) * 0.2)(512) * 16.0),
    }

def reference(A_x, A_k_cache, A_v_cache, A_wq, A_wo, B_x, B_w1, B_b1, B_w2, B_b2, gate_w):
    def _A_ref(x, k_cache, v_cache, wq, wo):
        B, Sq, D = x.shape
        Hq, Dh = 32, 128
        Hkv, Sk = k_cache.shape[1], k_cache.shape[2]
        W = min(4096, max(256, Sk // 4))
        rep = Hq // Hkv
        q = (lambda x, *d: x.permute(*d))((x @ wq).reshape(B, Sq, Hq, Dh), 0, 2, 1, 3)
        k = (lambda x, n, axis: torch.repeat_interleave(x, n, dim=axis))(k_cache[:, :, Sk - W:, :], rep, axis=1)
        v = (lambda x, n, axis: torch.repeat_interleave(x, n, dim=axis))(v_cache[:, :, Sk - W:, :], rep, axis=1)
        scores = torch.einsum("bhqd,bhkd->bhqk", q, k) * (Dh ** -0.5)
        p = _softmax(scores, axis=-1)
        o = torch.einsum("bhqk,bhkd->bhqd", p, v)
        return (lambda x, *d: x.permute(*d))(o, 0, 2, 1, 3).reshape(B, Sq, Hq * Dh) @ wo

    def _B_ref(x, w1, b1, w2, b2):
        h = torch.einsum("bsd,df->bsf", x, w1) + b1
        h = _gelu(h)
        return torch.einsum("bsf,fd->bsd", h, w2) + b2

    x = A_x
    g = _sigmoid((x * gate_w).sum(-1, keepdims=True))
    a = _A_ref(x, A_k_cache, A_v_cache, A_wq, A_wo)
    b = _B_ref(x, B_w1, B_b1, B_w2, B_b2)
    return g * a + (1 - g) * b
```

```asm
; @launch grid=(256,1,1) block=(512,1,1) lds=121344
.amdgcn_target "amdgcn-amd-amdhsa--gfx950"
.text
.globl gated_mix__sliding_block_cached__dense_activation_gelu__decode_kernel
.p2align 8
.type gated_mix__sliding_block_cached__dense_activation_gelu__decode_kernel,@function
gated_mix__sliding_block_cached__dense_activation_gelu__decode_kernel:
    s_load_dwordx16 s[8:23], s[0:1], 0
    s_cmp_ge_u32 s2, 256
    s_cbranch_scc1 L_end0
    v_lshrrev_b32 v1, 6, v0
    v_and_b32 v0, 63, v0
    s_and_b32 s4, s2, 7
    v_readfirstlane_b32 s3, v1
    s_lshr_b32 s5, s2, 3
    s_lshl_b32 s64, s4, 2
    s_lshr_b32 s65, s5, 3
    s_add_u32 s64, s64, s65
    s_and_b32 s65, s5, 7
    s_and_b32 s63, s5, 7
    v_lshrrev_b32 v1, 4, v0
    v_and_b32 v2, 15, v0
    s_mov_b32 s83, 0x40000
    s_mov_b32 s79, 0
    s_cmp_eq_u32 s3, 0
    s_cbranch_scc1 L_loader
    s_load_dwordx8 s[24:31], s[0:1], 64
    s_load_dwordx4 s[32:35], s[0:1], 96
    s_cmp_lt_u32 s3, 6
    s_cbranch_scc1 L_nopf
    s_getpc_b64 s[40:41]
L_pc:
    s_sub_u32 s6, s3, 6
    s_lshl_b32 s6, s6, 13
    v_lshlrev_b32 v5, 7, v0
    v_add_u32 v5, s6, v5
    v_min_u32 v5, L_codeend-L_pc-1024, v5
    global_load_dword v239, v5, s[40:41] offset:960
L_nopf:
    s_mov_b64 exec, 0
    s_cmp_eq_u32 s3, 2
    s_cbranch_scc1 PP_0
    s_cmp_eq_u32 s3, 3
    s_cbranch_scc1 PP_1
L_d1:
    s_mov_b64 exec, -1
    v_and_b32 v3, 1, v0
    v_lshlrev_b32 v4, 10, v3
    v_lshl_add_u32 v4, v1, 4, v4
    s_and_b32 s66, s5, 3
    s_lshl_b32 s68, s66, 8
    s_waitcnt lgkmcnt(0)
    s_load_dword s82, s[34:35], 0
    s_cmp_lg_u32 s3, 1
    s_cbranch_scc1 L_d2
    s_add_u32 s40, s8, s68
    s_addc_u32 s41, s9, 0
    global_load_dwordx4 v[16:19], v4, s[40:41] offset:0
    global_load_dwordx4 v[20:23], v4, s[40:41] offset:64
    global_load_dwordx4 v[24:27], v4, s[40:41] offset:128
    global_load_dwordx4 v[28:31], v4, s[40:41] offset:192
    s_barrier
    s_branch L_qprod
L_d2:
    s_barrier
    s_mov_b64 exec, 0
    s_cmp_eq_u32 s3, 4
    s_cbranch_scc1 PP_2
    s_cmp_eq_u32 s3, 5
    s_cbranch_scc1 PP_3
    s_cmp_eq_u32 s3, 6
    s_cbranch_scc1 PP_4
    s_cmp_eq_u32 s3, 7
    s_cbranch_scc1 PP_5
    s_cmp_eq_u32 s3, 3
    s_cbranch_scc1 PP_6
    s_cmp_eq_u32 s3, 2
    s_cbranch_scc1 PP_7
L_dispatch:
    s_mov_b64 exec, -1
    s_cmp_eq_u32 s3, 2
    s_cbranch_scc1 L_aux
    s_cmp_eq_u32 s3, 3
    s_cbranch_scc1 L_ffn
    s_branch L_core
L_end0:
    s_endpgm
L_loader:
    s_setprio 3
    v_mov_b32 v4, 0
    v_mov_b32 v5, 0
    v_lshlrev_b32 v3, 3, v0
    v_add_u32 v3, 117248, v3
    ds_write_b64 v3, v[4:5]
    v_lshrrev_b32 v10, 3, v0
    v_and_b32 v11, 7, v0
    v_and_b32 v12, 2, v10
    v_xor_b32 v11, v11, v12
    v_lshlrev_b32 v11, 4, v11
    v_lshl_add_u32 v18, v10, 13, v11
    v_xor_b32 v19, 64, v18
    v_lshl_add_u32 v12, v10, 10, v11
    v_xor_b32 v13, 64, v12
    v_mul_u32_u24 v14, 3584, v10
    v_add_u32 v14, v14, v11
    v_xor_b32 v15, 64, v14
    v_xor_b32 v3, v2, v1
    v_lshlrev_b32 v3, 4, v3
    v_lshl_add_u32 v4, v1, 8, v3
    v_xor_b32 v5, 64, v4
    v_xor_b32 v6, 0x80, v4
    v_xor_b32 v7, 0xc0, v4
    v_lshlrev_b32 v3, 1, v1
    v_xor_b32 v3, v2, v3
    v_lshlrev_b32 v3, 4, v3
    v_lshl_add_u32 v8, v1, 8, v3
    v_xor_b32 v9, 0x80, v8
    v_mov_b32 v16, 117504
    s_mov_b32 s70, 0
    s_lshr_b32 s75, s5, 4
    s_lshl_b32 s75, s75, 24
    s_lshl_b32 s7, s4, 21
    s_add_u32 s75, s75, s7
    s_and_b32 s7, s5, 15
    s_lshl_b32 s62, s7, 12
    s_lshl_b32 s7, s7, 15
    s_add_u32 s75, s75, s7
    s_add_u32 s75, s75, 0x180000
    s_mul_i32 s76, s65, 229376
    s_mul_i32 s7, s64, 112
    s_add_u32 s76, s76, s7
    s_lshl_b32 s74, s63, 12
    s_and_b32 s66, s5, 3
    s_lshr_b32 s67, s5, 2
    s_lshl_b32 s6, s66, 20
    s_lshl_b32 s7, s4, 10
    s_add_u32 s6, s6, s7
    s_lshl_b32 s7, s67, 7
    s_add_u32 s6, s6, s7
    s_mov_b32 s39, 0x20000
    s_waitcnt lgkmcnt(0)
    s_add_u32 s36, s14, s6
    s_addc_u32 s37, s15, 0
    s_mov_b32 s38, 1040512
    s_mov_b32 s7, 0
    s_mov_b32 m0, 0
    s_mov_b32 s70, 16
    buffer_load_dwordx4 v18, s[36:39], s7 offen offset:0 nt lds
    s_add_u32 s7, s7, 64512
    buffer_load_dwordx4 v19, s[36:39], s7 offen offset:1024 nt lds
    s_add_u32 s7, s7, 64512
    buffer_load_dwordx4 v18, s[36:39], s7 offen offset:2048 nt lds
    s_add_u32 s7, s7, 64512
    buffer_load_dwordx4 v19, s[36:39], s7 offen offset:3072 nt lds
    s_mov_b32 m0, 4096
    s_add_u32 s7, s7, 68608
    buffer_load_dwordx4 v18, s[36:39], s7 offen offset:0 nt lds
    s_add_u32 s7, s7, 64512
    buffer_load_dwordx4 v19, s[36:39], s7 offen offset:1024 nt lds
    s_add_u32 s7, s7, 64512
    buffer_load_dwordx4 v18, s[36:39], s7 offen offset:2048 nt lds
    s_add_u32 s7, s7, 64512
    buffer_load_dwordx4 v19, s[36:39], s7 offen offset:3072 nt lds
    s_mov_b32 m0, 8192
    s_add_u32 s7, s7, 68608
    buffer_load_dwordx4 v18, s[36:39], s7 offen offset:0 nt lds
    s_add_u32 s7, s7, 64512
    buffer_load_dwordx4 v19, s[36:39], s7 offen offset:1024 nt lds
    s_add_u32 s7, s7, 64512
    buffer_load_dwordx4 v18, s[36:39], s7 offen offset:2048 nt lds
    s_add_u32 s7, s7, 64512
    buffer_load_dwordx4 v19, s[36:39], s7 offen offset:3072 nt lds
    s_mov_b32 m0, 12288
    s_add_u32 s7, s7, 68608
    buffer_load_dwordx4 v18, s[36:39], s7 offen offset:0 nt lds
    s_add_u32 s7, s7, 64512
    buffer_load_dwordx4 v19, s[36:39], s7 offen offset:1024 nt lds
    s_add_u32 s7, s7, 64512
    buffer_load_dwordx4 v18, s[36:39], s7 offen offset:2048 nt lds
    s_add_u32 s7, s7, 64512
    buffer_load_dwordx4 v19, s[36:39], s7 offen offset:3072 nt lds
    s_load_dwordx8 s[24:31], s[0:1], 64
    s_load_dwordx4 s[32:35], s[0:1], 96
    s_barrier
    s_add_u32 s36, s20, s76
    s_addc_u32 s37, s21, 0
    s_mov_b32 s38, 225904
    s_mov_b32 s71, 0
    s_add_u32 s73, s70, 8
Lt_1:
    s_lshl_b32 s6, s71, 10
    s_add_u32 m0, s6, 49152
    s_mul_i32 s7, s71, 28672
    buffer_load_dwordx4 v14, s[36:39], s7 offen nt lds
    s_add_u32 m0, s6, 50176
    s_add_u32 s7, s7, 28672
    buffer_load_dwordx4 v15, s[36:39], s7 offen nt lds
    s_add_u32 s71, s71, 2
    s_add_u32 s70, s70, 2
PP_0:
    s_cbranch_execz L_d1
    s_waitcnt vmcnt(20)
    v_mov_b32 v17, s70
    ds_write_b32 v16, v17
    s_cmp_lt_u32 s70, s73
    s_cbranch_scc1 Lt_1
    s_add_u32 s36, s10, s75
    s_addc_u32 s37, s11, 0
    s_mov_b32 s38, 32768
    s_mov_b32 s7, s74
    s_mov_b32 m0, 16384
    s_add_u32 s73, s70, 32
Lk_2:
    buffer_load_dwordx4 v4, s[36:39], s7 offen offset:0 nt lds
    buffer_load_dwordx4 v5, s[36:39], s7 offen offset:1024 nt lds
    s_add_u32 s70, s70, 2
    s_waitcnt vmcnt(20)
    v_mov_b32 v17, s70
    ds_write_b32 v16, v17
    buffer_load_dwordx4 v6, s[36:39], s7 offen offset:2048 nt lds
    buffer_load_dwordx4 v7, s[36:39], s7 offen offset:3072 nt lds
    s_add_u32 s70, s70, 2
    s_add_u32 s7, s7, 4096
    s_and_b32 s7, s7, 0x7fff
    s_add_u32 m0, m0, 4096
    s_waitcnt vmcnt(20)
    v_mov_b32 v17, s70
    ds_write_b32 v16, v17
    s_cmp_lt_u32 s70, s73
    s_cbranch_scc1 Lk_2
    s_add_u32 s36, s12, s75
    s_addc_u32 s37, s13, 0
    s_mov_b32 s38, 32768
    s_mov_b32 s7, s74
    s_mov_b32 m0, 57344
    s_add_u32 s73, s70, 32
Lk_3:
    buffer_load_dwordx4 v8, s[36:39], s7 offen offset:0 nt lds
    buffer_load_dwordx4 v8, s[36:39], s7 offen offset:1024 nt lds
    s_add_u32 s70, s70, 2
    s_waitcnt vmcnt(20)
    v_mov_b32 v17, s70
    ds_write_b32 v16, v17
    buffer_load_dwordx4 v9, s[36:39], s7 offen offset:2048 nt lds
    buffer_load_dwordx4 v9, s[36:39], s7 offen offset:3072 nt lds
    s_add_u32 s70, s70, 2
    s_add_u32 s7, s7, 4096
    s_and_b32 s7, s7, 0x7fff
    s_add_u32 m0, m0, 4096
    s_waitcnt vmcnt(20)
    v_mov_b32 v17, s70
    ds_write_b32 v16, v17
    s_cmp_lt_u32 s70, s73
    s_cbranch_scc1 Lk_3
    s_waitcnt lgkmcnt(0)
    s_mul_i32 s6, s64, 57344
    s_lshl_b32 s7, s65, 7
    s_add_u32 s6, s6, s7
    s_add_u32 s36, s24, s6
    s_addc_u32 s37, s25, 0
    s_mov_b32 s38, 56448
    s_mov_b32 s71, 0
    s_add_u32 s73, s70, 8
Lt_4:
    s_lshl_b32 s6, s71, 10
    s_add_u32 m0, s6, 106496
    s_mul_i32 s7, s71, 8192
    buffer_load_dwordx4 v12, s[36:39], s7 offen nt lds
    s_add_u32 m0, s6, 107520
    s_add_u32 s7, s7, 8192
    buffer_load_dwordx4 v13, s[36:39], s7 offen nt lds
    s_add_u32 s71, s71, 2
    s_add_u32 s70, s70, 2
    s_waitcnt vmcnt(20)
    v_mov_b32 v17, s70
    ds_write_b32 v16, v17
    s_cmp_lt_u32 s70, s73
    s_cbranch_scc1 Lt_4
    s_lshl_b32 s6, s64, 17
    s_lshl_b32 s7, s65, 7
    s_add_u32 s6, s6, s7
    s_add_u32 s36, s16, s6
    s_addc_u32 s37, s17, 0
    s_mov_b32 s38, 130176
    s_lshl_b32 s72, s63, 1
    s_mov_b32 s71, s72
    s_add_u32 s73, s70, 16
Lt_5:
    s_lshl_b32 s6, s71, 10
    s_add_u32 m0, s6, 90112
    s_mul_i32 s7, s71, 8192
    buffer_load_dwordx4 v12, s[36:39], s7 offen nt lds
    s_add_u32 m0, s6, 91136
    s_add_u32 s7, s7, 8192
    buffer_load_dwordx4 v13, s[36:39], s7 offen nt lds
    s_add_u32 s71, s71, 2
    s_add_u32 s70, s70, 2
    s_and_b32 s71, s71, 15
    s_waitcnt vmcnt(20)
    v_mov_b32 v17, s70
    ds_write_b32 v16, v17
    s_cmp_lt_u32 s70, s73
    s_cbranch_scc1 Lt_5
    s_waitcnt vmcnt(16)
    v_mov_b32 v17, 116
    ds_write_b32 v16, v17
    s_waitcnt vmcnt(0)
    v_mov_b32 v17, 132
    ds_write_b32 v16, v17
    s_endpgm
L_qprod:
    s_setprio 2
    s_lshr_b32 s67, s5, 2
    v_lshrrev_b32 v8, 1, v2
    v_lshlrev_b32 v52, 16, v3
    v_lshl_add_u32 v52, v8, 6, v52
    v_lshl_add_u32 v52, v1, 4, v52
    s_lshl_b32 s6, s4, 13
    s_lshr_b32 s7, s67, 1
    s_lshl_b32 s7, s7, 11
    s_add_u32 s6, s6, s7
    s_lshl_b32 s7, s66, 9
    s_add_u32 s6, s6, s7
    s_and_b32 s7, s67, 1
    s_lshl_b32 s7, s7, 8
    s_add_u32 s6, s6, s7
    s_add_u32 s6, s6, 65536
    s_mov_b32 s74, 0x00ff00ff
    s_mov_b32 s75, 0x00ff00ff
    s_add_u32 s46, s34, s6
    s_addc_u32 s47, s35, 0
    s_mov_b64 exec, s[74:75]
    global_load_dword v60, v52, s[46:47]
    s_mov_b64 exec, -1
    s_add_u32 s48, s46, 2097152
    s_addc_u32 s49, s47, 0
    v_bfe_u32 v5, v0, 2, 2
    v_and_b32 v6, 3, v0
    v_lshl_add_u32 v7, v1, 3, v5
    v_lshlrev_b32 v7, 7, v7
    v_lshl_add_u32 v7, v6, 3, v7
    v_lshrrev_b32 v5, 1, v5
    v_and_b32 v6, 1, v1
    v_lshl_add_u32 v5, v6, 1, v5
    v_lshl_add_u32 v48, v5, 5, v7
    v_xor_b32 v49, 32, v48
    v_xor_b32 v50, 64, v48
    v_xor_b32 v51, 0x60, v48
    v_mov_b32 v54, 117504
    v_mov_b32 v57, 1
    s_waitcnt lgkmcnt(0)
    s_add_u32 s82, s82, 1
    s_and_b32 s80, s82, 0xff
    s_mov_b32 s81, 0xffffff00
    v_mov_b32 v55, s80
    s_waitcnt vmcnt(1)
    v_cmp_eq_u32 vcc, 0, v8
    s_nop 1
    v_cndmask_b32 v128, 0, v16, vcc
    v_cndmask_b32 v129, 0, v17, vcc
    v_cndmask_b32 v130, 0, v18, vcc
    v_cndmask_b32 v131, 0, v19, vcc
    v_cndmask_b32 v132, 0, v20, vcc
    v_cndmask_b32 v133, 0, v21, vcc
    v_cndmask_b32 v134, 0, v22, vcc
    v_cndmask_b32 v135, 0, v23, vcc
    v_cndmask_b32 v136, 0, v24, vcc
    v_cndmask_b32 v137, 0, v25, vcc
    v_cndmask_b32 v138, 0, v26, vcc
    v_cndmask_b32 v139, 0, v27, vcc
    v_cndmask_b32 v140, 0, v28, vcc
    v_cndmask_b32 v141, 0, v29, vcc
    v_cndmask_b32 v142, 0, v30, vcc
    v_cndmask_b32 v143, 0, v31, vcc
    v_cmp_eq_u32 vcc, 1, v8
    s_nop 1
    v_cndmask_b32 v144, 0, v16, vcc
    v_cndmask_b32 v145, 0, v17, vcc
    v_cndmask_b32 v146, 0, v18, vcc
    v_cndmask_b32 v147, 0, v19, vcc
    v_cndmask_b32 v148, 0, v20, vcc
    v_cndmask_b32 v149, 0, v21, vcc
    v_cndmask_b32 v150, 0, v22, vcc
    v_cndmask_b32 v151, 0, v23, vcc
    v_cndmask_b32 v152, 0, v24, vcc
    v_cndmask_b32 v153, 0, v25, vcc
    v_cndmask_b32 v154, 0, v26, vcc
    v_cndmask_b32 v155, 0, v27, vcc
    v_cndmask_b32 v156, 0, v28, vcc
    v_cndmask_b32 v157, 0, v29, vcc
    v_cndmask_b32 v158, 0, v30, vcc
    v_cndmask_b32 v159, 0, v31, vcc
    v_cmp_eq_u32 vcc, 2, v8
    s_nop 1
    v_cndmask_b32 v160, 0, v16, vcc
    v_cndmask_b32 v161, 0, v17, vcc
    v_cndmask_b32 v162, 0, v18, vcc
    v_cndmask_b32 v163, 0, v19, vcc
    v_cndmask_b32 v164, 0, v20, vcc
    v_cndmask_b32 v165, 0, v21, vcc
    v_cndmask_b32 v166, 0, v22, vcc
    v_cndmask_b32 v167, 0, v23, vcc
    v_cndmask_b32 v168, 0, v24, vcc
    v_cndmask_b32 v169, 0, v25, vcc
    v_cndmask_b32 v170, 0, v26, vcc
    v_cndmask_b32 v171, 0, v27, vcc
    v_cndmask_b32 v172, 0, v28, vcc
    v_cndmask_b32 v173, 0, v29, vcc
    v_cndmask_b32 v174, 0, v30, vcc
    v_cndmask_b32 v175, 0, v31, vcc
    v_cmp_eq_u32 vcc, 3, v8
    s_nop 1
    v_cndmask_b32 v176, 0, v16, vcc
    v_cndmask_b32 v177, 0, v17, vcc
    v_cndmask_b32 v178, 0, v18, vcc
    v_cndmask_b32 v179, 0, v19, vcc
    v_cndmask_b32 v180, 0, v20, vcc
PP_1:
    s_cbranch_execz L_d1
    v_cndmask_b32 v181, 0, v21, vcc
    v_cndmask_b32 v182, 0, v22, vcc
    v_cndmask_b32 v183, 0, v23, vcc
    v_cndmask_b32 v184, 0, v24, vcc
    v_cndmask_b32 v185, 0, v25, vcc
    v_cndmask_b32 v186, 0, v26, vcc
    v_cndmask_b32 v187, 0, v27, vcc
    v_cndmask_b32 v188, 0, v28, vcc
    v_cndmask_b32 v189, 0, v29, vcc
    v_cndmask_b32 v190, 0, v30, vcc
    v_cndmask_b32 v191, 0, v31, vcc
    s_cmp_ge_u32 s79, 24
    s_cbranch_scc1 Ls_7
Lp_6:
    s_sub_u32 s83, s83, 1
    s_cbranch_scc1 L_end
    ds_read_b32 v56, v54 offset:0
    s_waitcnt lgkmcnt(0)
    v_readfirstlane_b32 s79, v56
    s_cmp_lt_u32 s79, 24
    s_cbranch_scc1 Lp_6
Ls_7:
    ds_read_b64_tr_b16 v[64:65], v48 offset:0
    ds_read_b64_tr_b16 v[66:67], v48 offset:512
    ds_read_b64_tr_b16 v[68:69], v49 offset:0
    ds_read_b64_tr_b16 v[70:71], v49 offset:512
    ds_read_b64_tr_b16 v[72:73], v50 offset:0
    ds_read_b64_tr_b16 v[74:75], v50 offset:512
    ds_read_b64_tr_b16 v[76:77], v51 offset:0
    ds_read_b64_tr_b16 v[78:79], v51 offset:512
    s_waitcnt lgkmcnt(6)
    v_mfma_f32_16x16x32_bf16 v[80:83], v[64:67], v[128:131], 0
    s_waitcnt lgkmcnt(4)
    v_mfma_f32_16x16x32_bf16 v[80:83], v[68:71], v[144:147], v[80:83]
    s_waitcnt lgkmcnt(2)
    v_mfma_f32_16x16x32_bf16 v[80:83], v[72:75], v[160:163], v[80:83]
    s_waitcnt lgkmcnt(0)
    v_mfma_f32_16x16x32_bf16 v[80:83], v[76:79], v[176:179], v[80:83]
    s_cmp_ge_u32 s79, 28
    s_cbranch_scc1 Ls_9
Lp_8:
    s_sub_u32 s83, s83, 1
    s_cbranch_scc1 L_end
    ds_read_b32 v56, v54 offset:0
    s_waitcnt lgkmcnt(0)
    v_readfirstlane_b32 s79, v56
    s_cmp_lt_u32 s79, 28
    s_cbranch_scc1 Lp_8
Ls_9:
    ds_read_b64_tr_b16 v[64:65], v48 offset:4096
    ds_read_b64_tr_b16 v[66:67], v48 offset:4608
    ds_read_b64_tr_b16 v[68:69], v49 offset:4096
    ds_read_b64_tr_b16 v[70:71], v49 offset:4608
    ds_read_b64_tr_b16 v[72:73], v50 offset:4096
    ds_read_b64_tr_b16 v[74:75], v50 offset:4608
    ds_read_b64_tr_b16 v[76:77], v51 offset:4096
    ds_read_b64_tr_b16 v[78:79], v51 offset:4608
    s_waitcnt lgkmcnt(6)
    v_mfma_f32_16x16x32_bf16 v[80:83], v[64:67], v[132:135], v[80:83]
    s_waitcnt lgkmcnt(4)
    v_mfma_f32_16x16x32_bf16 v[80:83], v[68:71], v[148:151], v[80:83]
    s_waitcnt lgkmcnt(2)
    v_mfma_f32_16x16x32_bf16 v[80:83], v[72:75], v[164:167], v[80:83]
    s_waitcnt lgkmcnt(0)
    v_mfma_f32_16x16x32_bf16 v[80:83], v[76:79], v[180:183], v[80:83]
    s_cmp_ge_u32 s79, 32
    s_cbranch_scc1 Ls_11
Lp_10:
    s_sub_u32 s83, s83, 1
    s_cbranch_scc1 L_end
    ds_read_b32 v56, v54 offset:0
    s_waitcnt lgkmcnt(0)
    v_readfirstlane_b32 s79, v56
    s_cmp_lt_u32 s79, 32
    s_cbranch_scc1 Lp_10
Ls_11:
    ds_read_b64_tr_b16 v[64:65], v48 offset:8192
    ds_read_b64_tr_b16 v[66:67], v48 offset:8704
    ds_read_b64_tr_b16 v[68:69], v49 offset:8192
    ds_read_b64_tr_b16 v[70:71], v49 offset:8704
    ds_read_b64_tr_b16 v[72:73], v50 offset:8192
    ds_read_b64_tr_b16 v[74:75], v50 offset:8704
    ds_read_b64_tr_b16 v[76:77], v51 offset:8192
    ds_read_b64_tr_b16 v[78:79], v51 offset:8704
    s_waitcnt lgkmcnt(6)
    v_mfma_f32_16x16x32_bf16 v[80:83], v[64:67], v[136:139], v[80:83]
    s_waitcnt lgkmcnt(4)
    v_mfma_f32_16x16x32_bf16 v[80:83], v[68:71], v[152:155], v[80:83]
    s_waitcnt lgkmcnt(2)
    v_mfma_f32_16x16x32_bf16 v[80:83], v[72:75], v[168:171], v[80:83]
    s_waitcnt lgkmcnt(0)
    v_mfma_f32_16x16x32_bf16 v[80:83], v[76:79], v[184:187], v[80:83]
    s_cmp_ge_u32 s79, 36
    s_cbranch_scc1 Ls_13
Lp_12:
    s_sub_u32 s83, s83, 1
    s_cbranch_scc1 L_end
    ds_read_b32 v56, v54 offset:0
    s_waitcnt lgkmcnt(0)
    v_readfirstlane_b32 s79, v56
    s_cmp_lt_u32 s79, 36
    s_cbranch_scc1 Lp_12
Ls_13:
    ds_read_b64_tr_b16 v[64:65], v48 offset:12288
    ds_read_b64_tr_b16 v[66:67], v48 offset:12800
    ds_read_b64_tr_b16 v[68:69], v49 offset:12288
    ds_read_b64_tr_b16 v[70:71], v49 offset:12800
    ds_read_b64_tr_b16 v[72:73], v50 offset:12288
    ds_read_b64_tr_b16 v[74:75], v50 offset:12800
    ds_read_b64_tr_b16 v[76:77], v51 offset:12288
    ds_read_b64_tr_b16 v[78:79], v51 offset:12800
    s_waitcnt lgkmcnt(6)
    v_mfma_f32_16x16x32_bf16 v[80:83], v[64:67], v[140:143], v[80:83]
    s_waitcnt lgkmcnt(4)
    v_mfma_f32_16x16x32_bf16 v[80:83], v[68:71], v[156:159], v[80:83]
    s_waitcnt lgkmcnt(2)
    v_mfma_f32_16x16x32_bf16 v[80:83], v[72:75], v[172:175], v[80:83]
    s_waitcnt lgkmcnt(0)
    v_mfma_f32_16x16x32_bf16 v[80:83], v[76:79], v[188:191], v[80:83]
    s_mov_b64 exec, s[74:75]
    s_nop 6
    v_add_u32 v80, 0x80, v80
    v_add_u32 v81, 0x80, v81
    v_add_u32 v82, 0x80, v82
    v_add_u32 v83, 0x80, v83
    v_and_or_b32 v80, v80, s81, v55
    v_and_or_b32 v81, v81, s81, v55
    v_and_or_b32 v82, v82, s81, v55
    v_and_or_b32 v83, v83, s81, v55
    global_store_dwordx4 v52, v[80:83], s[46:47]
    global_store_dwordx4 v52, v[80:83], s[48:49] sc1
    ds_write_b32 v54, v57 offset:20
    s_mov_b64 exec, -1
    s_lshl_b32 s6, s4, 12
    s_lshl_b32 s7, s5, 7
    s_add_u32 s6, s6, s7
    s_add_u32 s6, s6, 327680
    v_and_b32 v9, 3, v0
    v_lshlrev_b32 v9, 4, v9
    v_add_u32 v9, 118272, v9
    v_lshlrev_b32 v10, 4, v0
    s_mov_b32 s69, 0x3fb8aa3b
    s_setprio 0
    s_add_u32 s44, s34, s6
    s_addc_u32 s45, s35, 0
    s_add_u32 s52, s44, 2097152
    s_addc_u32 s53, s45, 0
    s_lshr_b32 s6, s64, 2
    s_lshl_b32 s6, s6, 12
    s_and_b32 s7, s64, 3
    s_lshl_b32 s7, s7, 4
    s_add_u32 s6, s6, s7
    s_add_u32 s6, s6, 327680
    v_lshlrev_b32 v11, 7, v0
    v_lshlrev_b32 v12, 2, v0
    v_add_u32 v12, 118528, v12
    s_add_u32 s58, s34, s6
    s_addc_u32 s59, s35, 0
Lw_14:
    s_sleep 2
    s_sub_u32 s83, s83, 1
    s_cbranch_scc1 L_end
    ds_read_b32 v56, v54 offset:4
    s_waitcnt lgkmcnt(0)
    v_cmp_gt_u32 vcc, 4, v56
    s_cbranch_vccnz Lw_14
Lw_15:
    s_sub_u32 s83, s83, 1
    s_cbranch_scc1 L_end
    ds_read_b32 v56, v54 offset:28
    ds_read_b128 v[64:67], v9
    ds_read_b128 v[68:71], v9 offset:64
    s_waitcnt lgkmcnt(0)
    v_cmp_gt_u32 vcc, 4, v56
    s_cbranch_vccnz Lw_15
    v_max3_f32 v72, v64, v65, v66
    v_max_f32 v72, v72, v67
    v_sub_f32 v64, v64, v72
    v_sub_f32 v65, v65, v72
    v_sub_f32 v66, v66, v72
    v_sub_f32 v67, v67, v72
    v_mul_f32 v64, s69, v64
    v_mul_f32 v65, s69, v65
    v_mul_f32 v66, s69, v66
    v_mul_f32 v67, s69, v67
    v_exp_f32 v64, v64
    v_exp_f32 v65, v65
    v_exp_f32 v66, v66
    v_exp_f32 v67, v67
    v_mul_f32 v73, v64, v68
    v_fmac_f32 v73, v65, v69
    v_fmac_f32 v73, v66, v70
    v_fmac_f32 v73, v67, v71
    v_mov_b32 v74, v72
    v_mov_b32 v75, v73
    v_and_or_b32 v72, v72, s81, v55
    v_and_or_b32 v73, v73, s81, v55
    v_and_or_b32 v74, v74, s81, v55
    v_and_or_b32 v75, v75, s81, v55
    s_mov_b64 exec, 0xff
    global_store_dwordx4 v10, v[72:75], s[44:45]
PP_2:
    s_cbranch_execz PP_8
    s_mov_b64 exec, 0xffffffff
    s_mov_b32 s78, 256
Lm_16:
    s_sub_u32 s83, s83, 1
    s_cbranch_scc1 L_end
    s_sub_u32 s78, s78, 1
    s_cbranch_scc0 Lb_18
    s_mov_b64 s[36:37], exec
    s_mov_b64 exec, 0xff
    global_store_dwordx4 v10, v[72:75], s[52:53] sc1
    s_waitcnt vmcnt(0)
    s_mov_b64 exec, s[36:37]
    s_add_u32 s58, s58, 2097152
    s_addc_u32 s59, s59, 0
    s_mov_b32 s78, 0x7fffffff
Lb_18:
    global_load_dwordx4 v[32:35], v11, s[58:59] sc1
    s_waitcnt vmcnt(0)
    v_xor_b32 v32, s80, v32
    v_xor_b32 v33, s80, v33
    v_xor_b32 v34, s80, v34
    v_xor_b32 v35, s80, v35
    v_or3_b32 v56, v32, v33, v34
    v_or_b32 v56, v56, v35
    v_and_b32 v56, 0xff, v56
    v_cmp_ne_u32 vcc, 0, v56
    s_and_b64 exec, exec, vcc
    s_cbranch_scc1 Lm_16
    s_mov_b64 exec, 0xffffffff
    v_and_b32 v32, 0xffff0000, v32
    v_mov_b32 v34, v32
    s_nop 1
    v_max_f32_dpp v34, v34, v34 row_ror:1 row_mask:0xf bank_mask:0xf
    s_nop 1
    v_max_f32_dpp v34, v34, v34 row_ror:2 row_mask:0xf bank_mask:0xf
    s_nop 1
    v_max_f32_dpp v34, v34, v34 row_ror:4 row_mask:0xf bank_mask:0xf
    s_nop 1
    v_max_f32_dpp v34, v34, v34 row_ror:8 row_mask:0xf bank_mask:0xf
    v_sub_f32 v32, v32, v34
    v_mul_f32 v32, s69, v32
    v_exp_f32 v32, v32
    s_nop 0
    v_mul_f32 v33, v33, v32
    s_nop 1
    v_add_f32_dpp v33, v33, v33 row_ror:1 row_mask:0xf bank_mask:0xf
    s_nop 1
    v_add_f32_dpp v33, v33, v33 row_ror:2 row_mask:0xf bank_mask:0xf
    s_nop 1
    v_add_f32_dpp v33, v33, v33 row_ror:4 row_mask:0xf bank_mask:0xf
    s_nop 1
    v_add_f32_dpp v33, v33, v33 row_ror:8 row_mask:0xf bank_mask:0xf
    v_rcp_f32 v33, v33
    s_nop 0
    v_mul_f32 v32, v32, v33
    ds_write_b32 v12, v32
    ds_write_b32 v54, v57 offset:16
    s_mov_b32 s78, 200
Lw_19:
    s_sleep 2
    s_sub_u32 s78, s78, 1
    s_cbranch_scc1 Lx_20
    ds_read_b32 v56, v54 offset:12
    s_waitcnt lgkmcnt(0)
    v_cmp_gt_u32 vcc, 4, v56
    s_cbranch_vccnz Lw_19
Lx_20:
    s_mov_b64 exec, 0xff
    global_store_dwordx4 v10, v[72:75], s[52:53] sc1
    s_endpgm
L_core:
    s_setprio 2
    s_sub_u32 s66, s3, 4
    s_lshl_b32 s67, s66, 1
    v_lshlrev_b32 v22, 4, v0
    s_lshr_b32 s6, s5, 4
    s_lshl_b32 s6, s6, 16
    s_lshl_b32 s7, s4, 13
    s_add_u32 s6, s6, s7
    s_lshl_b32 s7, s66, 11
    s_add_u32 s6, s6, s7
    s_add_u32 s6, s6, 65536
    s_add_u32 s48, s34, s6
    s_addc_u32 s49, s35, 0
    v_and_b32 v5, 3, v2
    v_lshrrev_b32 v8, 2, v2
    v_mul_u32_u24 v6, 320, v5
    v_lshl_add_u32 v7, v1, 4, v6
    v_add_u32 v3, 114688, v7
    v_add_u32 v7, 115968, v7
    v_mov_b32 v9, 117248
    v_cmp_eq_u32 vcc, 0, v8
    s_nop 1
    v_cndmask_b32 v10, v9, v7, vcc
    v_cmp_eq_u32 vcc, 1, v8
    s_nop 1
    v_cndmask_b32 v11, v9, v7, vcc
    v_bfe_u32 v12, v0, 2, 2
    v_and_b32 v13, 3, v0
    v_lshl_add_u32 v14, v1, 3, v12
    v_and_b32 v15, 1, v1
    v_lshl_add_u32 v16, v15, 2, v12
    v_xor_b32 v16, s67, v16
    v_lshlrev_b32 v16, 5, v16
    v_lshl_add_u32 v16, v14, 8, v16
    v_lshl_add_u32 v16, v13, 3, v16
    v_add_u32 v16, 57344, v16
    v_xor_b32 v17, 32, v16
    v_lshrrev_b32 v18, 1, v12
    v_lshl_add_u32 v18, v15, 1, v18
    v_xor_b32 v18, s66, v18
    v_lshlrev_b32 v18, 5, v18
    v_lshl_add_u32 v18, v14, 7, v18
    v_lshl_add_u32 v18, v13, 3, v18
    v_add_u32 v18, 90112, v18
    v_mov_b32 v19, 117504
    v_lshlrev_b32 v20, 14, v5
    v_lshl_add_u32 v20, v8, 6, v20
    v_lshl_add_u32 v20, v1, 4, v20
    v_lshrrev_b32 v24, 5, v0
    v_add_u32 v25, s67, v24
    v_mul_u32_u24 v25, 288, v25
    v_and_b32 v26, 31, v0
    v_lshl_add_u32 v25, v26, 3, v25
    v_add_u32 v25, 118784, v25
    s_mul_i32 s6, s66, 320
    s_add_u32 s6, s6, 114688
    v_lshlrev_b32 v4, 3, v26
    v_lshl_add_u32 v4, v24, 2, v4
    v_add_u32 v4, s6, v4
    v_and_b32 v26, 7, v2
    v_mul_u32_u24 v26, 288, v26
    v_lshl_add_u32 v26, v1, 4, v26
    v_add_u32 v26, 118784, v26
    s_lshl_b32 s6, s66, 5
    s_add_u32 s6, s6, 118528
    v_lshlrev_b32 v27, 2, v24
    v_add_u32 v27, s6, v27
    v_xor_b32 v30, v1, v2
    v_lshlrev_b32 v30, 4, v30
    v_lshl_add_u32 v30, v2, 8, v30
    s_lshl_b32 s6, s66, 13
    s_add_u32 s6, s6, 16384
    v_add_u32 v30, s6, v30
    v_xor_b32 v31, 64, v30
    v_xor_b32 v248, 0x80, v30
    v_xor_b32 v249, 0xc0, v30
    v_lshrrev_b32 v12, 1, v8
    v_lshl_add_u32 v246, v12, 5, v6
    v_lshl_add_u32 v246, v1, 3, v246
    v_and_b32 v12, 1, v8
    v_lshl_add_u32 v246, v12, 2, v246
    s_lshl_b32 s6, s66, 6
    s_add_u32 s6, s6, 115968
    v_add_u32 v246, s6, v246
    v_lshlrev_b32 v245, 4, v5
    v_add_u32 v245, 118272, v245
    s_lshl_b32 s6, s66, 2
    v_add_u32 v244, s6, v245
    v_mov_b32 v247, 1
    s_lshl_b32 s6, s4, 16
    s_lshl_b32 s7, s5, 9
    s_add_u32 s6, s6, s7
    s_lshl_b32 s7, s66, 7
    s_add_u32 s6, s6, s7
    s_add_u32 s6, s6, 524288
    s_add_u32 s40, s34, s6
    s_addc_u32 s41, s35, 0
    s_add_u32 s50, s40, 2097152
    s_addc_u32 s51, s41, 0
    s_lshl_b32 s6, s64, 14
    s_lshl_b32 s7, s66, 12
    s_add_u32 s6, s6, s7
    s_add_u32 s6, s6, 524288
    s_add_u32 s42, s34, s6
    s_addc_u32 s43, s35, 0
    s_lshl_b32 s6, s65, 15
    s_lshl_b32 s7, s64, 9
    s_add_u32 s6, s6, s7
    s_lshl_b32 s7, s66, 7
    s_add_u32 s6, s6, s7
    s_add_u32 s6, s6, 1048576
    v_lshlrev_b32 v28, 6, v8
    v_lshl_add_u32 v28, v1, 4, v28
    s_add_u32 s46, s34, s6
    s_addc_u32 s47, s35, 0
    s_mov_b32 s68, 0x3db504f3
    s_mov_b32 s69, 0x3fb8aa3b
    s_lshl_b32 s70, s66, 3
    s_add_u32 s70, s70, 52
    s_mov_b32 s74, 16711935
    s_mov_b32 s75, 16711935
    s_mov_b32 s76, 1114129
    s_mov_b32 s77, 1114129
    s_waitcnt lgkmcnt(0)
    s_add_u32 s82, s82, 1
    s_and_b32 s80, s82, 0xff
    s_mov_b32 s81, 0xffffff00
    v_mov_b32 v21, s80
Lw_21:
    s_sleep 1
PP_3:
    s_cbranch_execz PP_9
    s_sub_u32 s83, s83, 1
    s_cbranch_scc1 L_end
    ds_read_b32 v29, v19 offset:20
    s_waitcnt lgkmcnt(0)
    v_cmp_gt_u32 vcc, 1, v29
    s_cbranch_vccnz Lw_21
    s_cmp_ge_u32 s79, 52
    s_cbranch_scc1 Ls_23
Lp_22:
    s_sleep 1
    s_sub_u32 s83, s83, 1
    s_cbranch_scc1 L_end
    ds_read_b32 v29, v19 offset:0
    s_waitcnt lgkmcnt(0)
    v_readfirstlane_b32 s79, v29
    s_cmp_lt_u32 s79, 52
    s_cbranch_scc1 Lp_22
Ls_23:
    s_mov_b32 s71, 0
    s_mov_b32 s78, 64
Lq_24:
    s_sub_u32 s83, s83, 1
    s_cbranch_scc1 L_end
    s_sub_u32 s78, s78, 1
    s_cbranch_scc0 Lb_26
    s_add_u32 s48, s48, 2097152
    s_addc_u32 s49, s49, 0
    s_mov_b32 s78, 0x7fffffff
Lb_26:
    global_load_dwordx4 v[208:211], v22, s[48:49] sc1
    global_load_dwordx4 v[212:215], v22, s[48:49] offset:1024 sc1
    s_cmp_lg_u32 s71, 0
    s_cbranch_scc1 Lk_27
    ds_read_b32 v29, v19 offset:0
    s_waitcnt lgkmcnt(0)
    v_readfirstlane_b32 s79, v29
    s_cmp_lt_u32 s79, s70
    s_cbranch_scc1 Lk_27
    s_mov_b32 s71, 1
    ds_read_b128 v[96:99], v30 offset:0
    ds_read_b128 v[100:103], v31 offset:0
    ds_read_b128 v[104:107], v248 offset:0
    ds_read_b128 v[108:111], v249 offset:0
    ds_read_b128 v[112:115], v30 offset:4096
    ds_read_b128 v[116:119], v31 offset:4096
    ds_read_b128 v[120:123], v248 offset:4096
    ds_read_b128 v[124:127], v249 offset:4096
Lk_27:
    s_waitcnt vmcnt(0)
    v_xor_b32 v208, s80, v208
    v_xor_b32 v209, s80, v209
    v_xor_b32 v210, s80, v210
    v_xor_b32 v211, s80, v211
    v_xor_b32 v212, s80, v212
    v_xor_b32 v213, s80, v213
    v_xor_b32 v214, s80, v214
    v_xor_b32 v215, s80, v215
    v_or3_b32 v29, v208, v209, v210
    v_or3_b32 v29, v29, v211, v212
    v_or3_b32 v29, v29, v213, v214
    v_or_b32 v29, v29, v215
    v_and_b32 v29, 0xff, v29
    v_cmp_ne_u32 vcc, 0, v29
    v_add_f32 v32, v208, v212
    v_add_f32 v33, v209, v213
    v_add_f32 v34, v210, v214
    v_add_f32 v35, v211, v215
    s_cbranch_vccnz Lq_24
    v_permlane32_swap_b32 v32, v34
    v_permlane32_swap_b32 v33, v35
    v_add_f32 v32, v32, v34
    v_add_f32 v33, v33, v35
    v_cvt_pk_bf16_f32 v32, v32, v33
    ds_write_b32 v4, v32
    s_mov_b64 exec, 1
    ds_add_u32 v19, v247 offset:4
    s_mov_b64 exec, -1
    s_cmp_lg_u32 s71, 0
    s_cbranch_scc1 Lk_28
    s_cmp_ge_u32 s79, s70
    s_cbranch_scc1 Ls_30
Lp_29:
    s_sub_u32 s83, s83, 1
    s_cbranch_scc1 L_end
    ds_read_b32 v29, v19 offset:0
    s_waitcnt lgkmcnt(0)
    v_readfirstlane_b32 s79, v29
    s_cmp_lt_u32 s79, s70
    s_cbranch_scc1 Lp_29
Ls_30:
    ds_read_b128 v[96:99], v30 offset:0
    ds_read_b128 v[100:103], v31 offset:0
    ds_read_b128 v[104:107], v248 offset:0
    ds_read_b128 v[108:111], v249 offset:0
    ds_read_b128 v[112:115], v30 offset:4096
    ds_read_b128 v[116:119], v31 offset:4096
    ds_read_b128 v[120:123], v248 offset:4096
    ds_read_b128 v[124:127], v249 offset:4096
Lk_28:
Lw_31:
    s_sub_u32 s83, s83, 1
    s_cbranch_scc1 L_end
    ds_read_b32 v29, v19 offset:4
    ds_read_b128 v[40:43], v3 offset:0
    ds_read_b128 v[44:47], v3 offset:64
    ds_read_b128 v[48:51], v3 offset:128
    ds_read_b128 v[52:55], v3 offset:192
    ds_read_b32 v243, v19 offset:0
    s_waitcnt lgkmcnt(0)
    v_cmp_gt_u32 vcc, 4, v29
    s_cbranch_vccnz Lw_31
    v_mfma_f32_16x16x32_bf16 v[56:59], v[96:99], v[40:43], 0
    v_mfma_f32_16x16x32_bf16 v[60:63], v[112:115], v[40:43], 0
    v_readfirstlane_b32 s79, v243
    s_mov_b32 s71, 0
    v_mfma_f32_16x16x32_bf16 v[56:59], v[100:103], v[44:47], v[56:59]
    v_mfma_f32_16x16x32_bf16 v[60:63], v[116:119], v[44:47], v[60:63]
    v_mfma_f32_16x16x32_bf16 v[56:59], v[104:107], v[48:51], v[56:59]
    v_mfma_f32_16x16x32_bf16 v[60:63], v[120:123], v[48:51], v[60:63]
    v_mfma_f32_16x16x32_bf16 v[56:59], v[108:111], v[52:55], v[56:59]
    v_mfma_f32_16x16x32_bf16 v[60:63], v[124:127], v[52:55], v[60:63]
    s_nop 6
    v_max3_f32 v33, v56, v57, v58
    v_max3_f32 v34, v60, v61, v62
    v_mov_b32_dpp v56, v58 quad_perm:[0,1,2,3] row_mask:0xf bank_mask:0x2
    v_max3_f32 v33, v33, v59, v63
    v_mov_b32_dpp v57, v59 quad_perm:[0,1,2,3] row_mask:0xf bank_mask:0x2
    v_max_f32 v33, v33, v34
    v_mov_b32_dpp v56, v60 quad_perm:[0,1,2,3] row_mask:0xf bank_mask:0x4
    v_mov_b32 v34, v33
    v_mov_b32_dpp v57, v61 quad_perm:[0,1,2,3] row_mask:0xf bank_mask:0x4
    v_mov_b32_dpp v56, v62 quad_perm:[0,1,2,3] row_mask:0xf bank_mask:0x8
    v_permlane16_swap_b32 v33, v34
    v_mov_b32_dpp v57, v63 quad_perm:[0,1,2,3] row_mask:0xf bank_mask:0x8
    v_max_f32 v33, v33, v34
    v_mov_b32 v34, v33
    v_cvt_pk_bf16_f32 v58, v56, v57
    v_lshlrev_b32 v56, 16, v58
    v_permlane32_swap_b32 v33, v34
    v_and_b32 v57, 0xffff0000, v58
    v_max_f32 v33, v33, v34
    v_mul_f32 v56, s68, v56
    v_cvt_pk_bf16_f32 v33, v33, v33
    v_mul_f32 v57, s68, v57
    v_and_b32 v33, 0xffff0000, v33
    v_cvt_pk_bf16_f32 v58, v56, v57
    v_mul_f32 v33, s68, v33
    v_lshlrev_b32 v56, 16, v58
    v_cvt_pk_bf16_f32 v33, v33, v33
    v_and_b32 v57, 0xffff0000, v58
    v_and_b32 v60, 0xffff0000, v33
    v_sub_f32 v56, v56, v60
    v_sub_f32 v57, v57, v60
    ds_write_b32 v244, v60
    v_mul_f32 v56, s69, v56
    v_mul_f32 v57, s69, v57
    v_exp_f32 v56, v56
    v_exp_f32 v57, v57
    s_nop 0
    v_cvt_pk_bf16_f32 v58, v56, v57
    v_add_f32 v61, v56, v57
    ds_write_b32 v246, v58
    s_mov_b64 exec, 1
    ds_add_u32 v19, v247 offset:8
    s_mov_b64 exec, -1
    s_cmp_lt_u32 s79, 84
    s_cbranch_scc1 Lv_32
    ds_read_b64_tr_b16 v[160:161], v16 offset:0
    ds_read_b64_tr_b16 v[162:163], v16 offset:1024
    ds_read_b64_tr_b16 v[164:165], v17 offset:0
    ds_read_b64_tr_b16 v[166:167], v17 offset:1024
    s_mov_b32 s71, 1
    s_cmp_lt_u32 s79, 92
    s_cbranch_scc1 Lv_32
    ds_read_b64_tr_b16 v[168:169], v16 offset:8192
    ds_read_b64_tr_b16 v[170:171], v16 offset:9216
    ds_read_b64_tr_b16 v[172:173], v17 offset:8192
    ds_read_b64_tr_b16 v[174:175], v17 offset:9216
    s_mov_b32 s71, 2
    s_cmp_lt_u32 s79, 100
    s_cbranch_scc1 Lv_32
    ds_read_b64_tr_b16 v[176:177], v16 offset:16384
    ds_read_b64_tr_b16 v[178:179], v16 offset:17408
    ds_read_b64_tr_b16 v[180:181], v17 offset:16384
    ds_read_b64_tr_b16 v[182:183], v17 offset:17408
    s_mov_b32 s71, 3
    s_cmp_lt_u32 s79, 108
    s_cbranch_scc1 Lv_32
    ds_read_b64_tr_b16 v[184:185], v16 offset:24576
    ds_read_b64_tr_b16 v[186:187], v16 offset:25600
    ds_read_b64_tr_b16 v[188:189], v17 offset:24576
    ds_read_b64_tr_b16 v[190:191], v17 offset:25600
    s_mov_b32 s71, 4
Lv_32:
    v_add_f32_dpp v61, v61, v61 row_ror:4 row_mask:0xf bank_mask:0xf
PP_4:
    s_cbranch_execz L_dispatch
    s_nop 1
    v_add_f32_dpp v61, v61, v61 row_ror:8 row_mask:0xf bank_mask:0xf
    v_mov_b32 v62, v61
    s_nop 1
    v_permlane16_swap_b32 v61, v62
    v_add_f32 v61, v61, v62
    v_mov_b32 v62, v61
    s_nop 1
    v_permlane32_swap_b32 v61, v62
    v_add_f32 v61, v61, v62
    ds_write_b32 v244, v61 offset:64
    s_mov_b64 exec, 1
    ds_add_u32 v19, v247 offset:28
    s_mov_b64 exec, -1
Lw_33:
    s_sub_u32 s83, s83, 1
    s_cbranch_scc1 L_end
    ds_read_b32 v29, v19 offset:8
    ds_read_b128 v[128:131], v10 offset:0
    ds_read_b128 v[144:147], v11 offset:0
    ds_read_b128 v[132:135], v10 offset:64
    ds_read_b128 v[148:151], v11 offset:64
    ds_read_b128 v[136:139], v10 offset:128
    ds_read_b128 v[152:155], v11 offset:128
    ds_read_b128 v[140:143], v10 offset:192
    ds_read_b128 v[156:159], v11 offset:192
    ds_read_b128 v[64:67], v245
    ds_read_b32 v243, v19 offset:0
    s_waitcnt lgkmcnt(0)
    v_cmp_gt_u32 vcc, 4, v29
    s_cbranch_vccnz Lw_33
    v_readfirstlane_b32 s79, v243
    s_cmp_gt_u32 s71, 0
    s_cbranch_scc1 Lh_34
    s_cmp_ge_u32 s79, 84
    s_cbranch_scc1 Ls_36
Lp_35:
    s_sub_u32 s83, s83, 1
    s_cbranch_scc1 L_end
    ds_read_b32 v29, v19 offset:0
    s_waitcnt lgkmcnt(0)
    v_readfirstlane_b32 s79, v29
    s_cmp_lt_u32 s79, 84
    s_cbranch_scc1 Lp_35
Ls_36:
    ds_read_b64_tr_b16 v[160:161], v16 offset:0
    ds_read_b64_tr_b16 v[162:163], v16 offset:1024
    ds_read_b64_tr_b16 v[164:165], v17 offset:0
    ds_read_b64_tr_b16 v[166:167], v17 offset:1024
    s_waitcnt lgkmcnt(0)
Lh_34:
    v_mfma_f32_16x16x32_bf16 v[192:195], v[160:163], v[128:131], 0
    v_mfma_f32_16x16x32_bf16 v[192:195], v[164:167], v[144:147], v[192:195]
    v_max3_f32 v72, v64, v65, v66
    v_max_f32 v72, v72, v67
    v_sub_f32 v64, v64, v72
    v_sub_f32 v65, v65, v72
    v_sub_f32 v66, v66, v72
    v_sub_f32 v67, v67, v72
    s_cmp_gt_u32 s71, 1
    s_cbranch_scc1 Lh_37
    s_cmp_ge_u32 s79, 92
    s_cbranch_scc1 Ls_39
Lp_38:
    s_sub_u32 s83, s83, 1
    s_cbranch_scc1 L_end
    ds_read_b32 v29, v19 offset:0
    s_waitcnt lgkmcnt(0)
    v_readfirstlane_b32 s79, v29
    s_cmp_lt_u32 s79, 92
    s_cbranch_scc1 Lp_38
Ls_39:
    ds_read_b64_tr_b16 v[168:169], v16 offset:8192
    ds_read_b64_tr_b16 v[170:171], v16 offset:9216
    ds_read_b64_tr_b16 v[172:173], v17 offset:8192
    ds_read_b64_tr_b16 v[174:175], v17 offset:9216
    s_waitcnt lgkmcnt(0)
Lh_37:
    v_mfma_f32_16x16x32_bf16 v[196:199], v[168:171], v[132:135], 0
    v_mfma_f32_16x16x32_bf16 v[196:199], v[172:175], v[148:151], v[196:199]
    v_mul_f32 v64, s69, v64
    v_mul_f32 v65, s69, v65
    v_mul_f32 v66, s69, v66
    v_mul_f32 v67, s69, v67
    v_exp_f32 v64, v64
    v_exp_f32 v65, v65
    s_cmp_gt_u32 s71, 2
    s_cbranch_scc1 Lh_40
    s_cmp_ge_u32 s79, 100
    s_cbranch_scc1 Ls_42
Lp_41:
    s_sub_u32 s83, s83, 1
    s_cbranch_scc1 L_end
    ds_read_b32 v29, v19 offset:0
    s_waitcnt lgkmcnt(0)
    v_readfirstlane_b32 s79, v29
    s_cmp_lt_u32 s79, 100
    s_cbranch_scc1 Lp_41
Ls_42:
    ds_read_b64_tr_b16 v[176:177], v16 offset:16384
    ds_read_b64_tr_b16 v[178:179], v16 offset:17408
    ds_read_b64_tr_b16 v[180:181], v17 offset:16384
    ds_read_b64_tr_b16 v[182:183], v17 offset:17408
    s_waitcnt lgkmcnt(0)
Lh_40:
    v_mfma_f32_16x16x32_bf16 v[200:203], v[176:179], v[136:139], 0
    v_mfma_f32_16x16x32_bf16 v[200:203], v[180:183], v[152:155], v[200:203]
    v_exp_f32 v66, v66
    v_exp_f32 v67, v67
    v_mul_f32 v76, v64, v192
    v_mul_f32 v77, v64, v193
    v_mul_f32 v78, v64, v194
    v_mul_f32 v79, v64, v195
    s_cmp_gt_u32 s71, 3
    s_cbranch_scc1 Lh_43
    s_cmp_ge_u32 s79, 108
    s_cbranch_scc1 Ls_45
Lp_44:
    s_sub_u32 s83, s83, 1
    s_cbranch_scc1 L_end
    ds_read_b32 v29, v19 offset:0
    s_waitcnt lgkmcnt(0)
    v_readfirstlane_b32 s79, v29
    s_cmp_lt_u32 s79, 108
    s_cbranch_scc1 Lp_44
Ls_45:
    ds_read_b64_tr_b16 v[184:185], v16 offset:24576
    ds_read_b64_tr_b16 v[186:187], v16 offset:25600
    ds_read_b64_tr_b16 v[188:189], v17 offset:24576
    ds_read_b64_tr_b16 v[190:191], v17 offset:25600
    s_waitcnt lgkmcnt(0)
Lh_43:
    v_mfma_f32_16x16x32_bf16 v[204:207], v[184:187], v[140:143], 0
    v_mfma_f32_16x16x32_bf16 v[204:207], v[188:191], v[156:159], v[204:207]
    v_fmac_f32 v76, v65, v196
    v_fmac_f32 v77, v65, v197
    v_fmac_f32 v78, v65, v198
    v_fmac_f32 v79, v65, v199
    v_fmac_f32 v76, v66, v200
    v_fmac_f32 v77, v66, v201
    v_fmac_f32 v78, v66, v202
    v_fmac_f32 v79, v66, v203
    s_mov_b64 exec, s[74:75]
    v_fmac_f32 v76, v67, v204
    v_fmac_f32 v77, v67, v205
    v_fmac_f32 v78, v67, v206
    v_fmac_f32 v79, v67, v207
    v_and_or_b32 v76, v76, s81, v21
    v_and_or_b32 v77, v77, s81, v21
    v_and_or_b32 v78, v78, s81, v21
    v_and_or_b32 v79, v79, s81, v21
    global_store_dwordx4 v20, v[76:79], s[40:41]
    s_mov_b64 exec, -1
    s_mov_b64 s[56:57], s[74:75]
    s_cmp_ge_u32 s79, 116
    s_cbranch_scc1 Ls_49
Lp_48:
    s_sub_u32 s83, s83, 1
    s_cbranch_scc1 L_end
    ds_read_b32 v29, v19 offset:0
    s_waitcnt lgkmcnt(0)
    v_readfirstlane_b32 s79, v29
    s_cmp_lt_u32 s79, 116
    s_cbranch_scc1 Lp_48
Ls_49:
    global_load_dwordx4 v[40:43], v22, s[42:43] offset:0 sc1
    global_load_dwordx4 v[44:47], v22, s[42:43] offset:1024 sc1
    global_load_dwordx4 v[48:51], v22, s[42:43] offset:2048 sc1
    global_load_dwordx4 v[52:55], v22, s[42:43] offset:3072 sc1
    s_mov_b32 s78, 256
    s_mov_b32 s71, 0
Lc_46:
    ds_read_b32 v240, v19 offset:16
    ds_read_b32 v36, v27 offset:0
    ds_read_b32 v37, v27 offset:8
    ds_read_b32 v38, v27 offset:16
    ds_read_b32 v39, v27 offset:24
    ds_read_b32 v243, v19 offset:0
    s_sub_u32 s83, s83, 1
    s_cbranch_scc1 L_end
    s_sub_u32 s78, s78, 1
    s_cbranch_scc0 Lb_51
    s_mov_b64 exec, s[56:57]
    s_cbranch_execz Lk_52
    global_store_dwordx4 v20, v[76:79], s[50:51] sc1
    s_mov_b64 s[56:57], 0
Lk_52:
    s_mov_b64 exec, -1
    s_add_u32 s42, s42, 2097152
    s_addc_u32 s43, s43, 0
    s_mov_b32 s78, 0x7fffffff
Lb_51:
    s_waitcnt lgkmcnt(0)
    v_xor_b32 v240, 1, v240
    s_cmp_lg_u32 s71, 0
    s_cbranch_scc1 Lw_50
    v_readfirstlane_b32 s79, v243
    s_cmp_lt_u32 s79, 132
    s_cbranch_scc1 Lw_50
    s_mov_b32 s71, 1
    ds_read_b64_tr_b16 v[80:81], v18 offset:0
    ds_read_b64_tr_b16 v[82:83], v18 offset:512
    ds_read_b64_tr_b16 v[84:85], v18 offset:4096
    ds_read_b64_tr_b16 v[86:87], v18 offset:4608
    ds_read_b64_tr_b16 v[88:89], v18 offset:8192
    ds_read_b64_tr_b16 v[90:91], v18 offset:8704
    ds_read_b64_tr_b16 v[92:93], v18 offset:12288
PP_5:
    s_cbranch_execz L_dispatch
    ds_read_b64_tr_b16 v[94:95], v18 offset:12800
Lw_50:
    s_waitcnt vmcnt(0)
    v_xor_b32 v208, s80, v40
    v_xor_b32 v209, s80, v41
    v_xor_b32 v210, s80, v42
    v_xor_b32 v211, s80, v43
    v_or3_b32 v29, v208, v209, v210
    v_or_b32 v29, v29, v211
    v_mul_f32 v56, v36, v208
    v_mul_f32 v57, v36, v209
    v_mul_f32 v58, v36, v210
    v_mul_f32 v59, v36, v211
    v_xor_b32 v212, s80, v44
    v_xor_b32 v213, s80, v45
    v_xor_b32 v214, s80, v46
    v_xor_b32 v215, s80, v47
    v_or3_b32 v241, v212, v213, v214
    v_or_b32 v241, v241, v215
    v_fmac_f32 v56, v37, v212
    v_fmac_f32 v57, v37, v213
    v_fmac_f32 v58, v37, v214
    v_fmac_f32 v59, v37, v215
    v_xor_b32 v216, s80, v48
    v_xor_b32 v217, s80, v49
    v_xor_b32 v218, s80, v50
    v_xor_b32 v219, s80, v51
    v_or3_b32 v242, v216, v217, v218
    v_or_b32 v242, v242, v219
    v_fmac_f32 v56, v38, v216
    v_fmac_f32 v57, v38, v217
    v_fmac_f32 v58, v38, v218
    v_fmac_f32 v59, v38, v219
    v_xor_b32 v220, s80, v52
    v_xor_b32 v221, s80, v53
    v_xor_b32 v222, s80, v54
    v_xor_b32 v223, s80, v55
    v_or3_b32 v237, v220, v221, v222
    v_or_b32 v237, v237, v223
    v_fmac_f32 v56, v39, v220
    v_fmac_f32 v57, v39, v221
    v_fmac_f32 v58, v39, v222
    v_fmac_f32 v59, v39, v223
    v_or3_b32 v240, v240, v29, v241
    v_or3_b32 v240, v240, v242, v237
    v_and_b32 v240, 0xff, v240
    v_cmp_ne_u32 vcc, 0, v240
    v_cvt_pk_bf16_f32 v60, v56, v57
    v_cvt_pk_bf16_f32 v61, v58, v59
    s_cbranch_vccz Ld_47
    v_and_b32 v29, 0xff, v29
    v_and_b32 v241, 0xff, v241
    v_and_b32 v242, 0xff, v242
    v_and_b32 v237, 0xff, v237
    v_cmp_ne_u32 s[10:11], 0, v29
    v_cmp_ne_u32 s[12:13], 0, v241
    v_cmp_ne_u32 s[14:15], 0, v242
    v_cmp_ne_u32 s[16:17], 0, v237
Lr_53:
    s_mov_b64 exec, s[10:11]
    s_cbranch_execz Ln_54
    global_load_dwordx4 v[40:43], v22, s[42:43] offset:0 sc1
Ln_54:
    s_mov_b64 exec, s[12:13]
    s_cbranch_execz Ln_55
    global_load_dwordx4 v[44:47], v22, s[42:43] offset:1024 sc1
Ln_55:
    s_mov_b64 exec, s[14:15]
    s_cbranch_execz Ln_56
    global_load_dwordx4 v[48:51], v22, s[42:43] offset:2048 sc1
Ln_56:
    s_mov_b64 exec, s[16:17]
    s_cbranch_execz Ln_57
    global_load_dwordx4 v[52:55], v22, s[42:43] offset:3072 sc1
Ln_57:
    s_mov_b64 exec, -1
    s_branch Lc_46
Ld_47:
    ds_write_b64 v25, v[60:61]
    s_mov_b64 exec, 1
    ds_add_u32 v19, v247 offset:12
    s_mov_b64 exec, -1
    s_cmp_lg_u32 s71, 0
    s_cbranch_scc1 Lw_58
    s_cmp_ge_u32 s79, 132
    s_cbranch_scc1 Ls_60
Lp_59:
    s_sub_u32 s83, s83, 1
    s_cbranch_scc1 L_end
    ds_read_b32 v29, v19 offset:0
    s_waitcnt lgkmcnt(0)
    v_readfirstlane_b32 s79, v29
    s_cmp_lt_u32 s79, 132
    s_cbranch_scc1 Lp_59
Ls_60:
    ds_read_b64_tr_b16 v[80:81], v18 offset:0
    ds_read_b64_tr_b16 v[82:83], v18 offset:512
    ds_read_b64_tr_b16 v[84:85], v18 offset:4096
    ds_read_b64_tr_b16 v[86:87], v18 offset:4608
    ds_read_b64_tr_b16 v[88:89], v18 offset:8192
    ds_read_b64_tr_b16 v[90:91], v18 offset:8704
    ds_read_b64_tr_b16 v[92:93], v18 offset:12288
    ds_read_b64_tr_b16 v[94:95], v18 offset:12800
Lw_58:
Lw_61:
    s_sub_u32 s83, s83, 1
    s_cbranch_scc1 L_end
    ds_read_b32 v29, v19 offset:12
    ds_read_b128 v[40:43], v26 offset:0
    ds_read_b128 v[44:47], v26 offset:64
    ds_read_b128 v[48:51], v26 offset:128
    ds_read_b128 v[52:55], v26 offset:192
    s_waitcnt lgkmcnt(0)
    v_cmp_gt_u32 vcc, 4, v29
    s_cbranch_vccnz Lw_61
    v_mfma_f32_16x16x32_bf16 v[72:75], v[80:83], v[40:43], 0
    v_mfma_f32_16x16x32_bf16 v[72:75], v[84:87], v[44:47], v[72:75]
    v_mfma_f32_16x16x32_bf16 v[72:75], v[88:91], v[48:51], v[72:75]
    v_mfma_f32_16x16x32_bf16 v[72:75], v[92:95], v[52:55], v[72:75]
    s_nop 7
    v_add_f32_dpp v72, v72, v72 quad_perm:[1,0,3,2] row_mask:0xf bank_mask:0xf
    v_add_f32_dpp v73, v73, v73 quad_perm:[1,0,3,2] row_mask:0xf bank_mask:0xf
    v_add_f32_dpp v74, v74, v74 quad_perm:[1,0,3,2] row_mask:0xf bank_mask:0xf
    v_add_f32_dpp v75, v75, v75 quad_perm:[1,0,3,2] row_mask:0xf bank_mask:0xf
    v_add_f32_dpp v72, v72, v72 quad_perm:[2,3,0,1] row_mask:0xf bank_mask:0xf
    v_add_f32_dpp v73, v73, v73 quad_perm:[2,3,0,1] row_mask:0xf bank_mask:0xf
    v_add_f32_dpp v74, v74, v74 quad_perm:[2,3,0,1] row_mask:0xf bank_mask:0xf
    v_add_f32_dpp v75, v75, v75 quad_perm:[2,3,0,1] row_mask:0xf bank_mask:0xf
    s_mov_b64 exec, s[76:77]
    v_and_or_b32 v72, v72, s81, v21
    v_and_or_b32 v73, v73, s81, v21
    v_and_or_b32 v74, v74, s81, v21
    v_and_or_b32 v75, v75, s81, v21
    global_store_dwordx4 v28, v[72:75], s[46:47] sc1
    s_mov_b64 exec, s[56:57]
    s_cbranch_execz Lk_62
    global_store_dwordx4 v20, v[76:79], s[50:51] sc1
    s_mov_b64 s[56:57], 0
Lk_62:
    s_mov_b64 exec, -1
    s_endpgm
L_ffn:
    s_lshl_b32 s69, s65, 7
    s_add_u32 s40, s8, s69
    s_addc_u32 s41, s9, 0
    global_load_dwordx4 v[16:19], v4, s[40:41] offset:0
    global_load_dwordx4 v[20:23], v4, s[40:41] offset:64
    s_mul_i32 s7, s64, 112
    s_add_u32 s42, s22, s7
    s_addc_u32 s43, s23, 0
    v_min_u32 v8, 13, v2
    v_lshlrev_b32 v8, 3, v8
    global_load_dwordx2 v[24:25], v8, s[42:43]
    v_bfe_u32 v5, v0, 2, 2
    v_and_b32 v6, 3, v0
    v_lshl_add_u32 v7, v1, 3, v5
    v_lshlrev_b32 v7, 7, v7
    v_lshl_add_u32 v7, v6, 3, v7
    v_lshrrev_b32 v5, 1, v5
    v_and_b32 v6, 1, v1
    v_lshl_add_u32 v5, v6, 1, v5
    v_lshl_add_u32 v48, v5, 5, v7
    v_xor_b32 v49, 32, v48
    v_xor_b32 v50, 64, v48
    v_xor_b32 v51, 0x60, v48
    v_lshrrev_b32 v8, 1, v2
    v_lshlrev_b32 v52, 11, v3
    v_lshl_add_u32 v52, v8, 6, v52
    v_lshl_add_u32 v52, v1, 4, v52
    v_lshlrev_b32 v53, 11, v6
    v_lshl_add_u32 v53, v2, 4, v53
    v_mul_u32_u24 v9, 160, v6
    v_lshl_add_u32 v9, v2, 3, v9
    v_add_u32 v9, 117760, v9
    v_mul_u32_u24 v10, 160, v3
    v_lshl_add_u32 v10, v1, 4, v10
    v_add_u32 v10, 117760, v10
    v_mov_b32 v11, 117248
    v_add_u32 v44, 106496, v48
    v_add_u32 v45, 106496, v49
    v_add_u32 v46, 106496, v50
    v_add_u32 v47, 106496, v51
    v_mov_b32 v54, 117504
    v_mov_b32 v26, 0
    v_mov_b32 v27, 0
    s_lshl_b32 s6, s64, 12
    s_add_u32 s6, s6, 196608
    s_add_u32 s44, s34, s6
    s_addc_u32 s45, s35, 0
    s_lshl_b32 s7, s65, 8
    s_add_u32 s6, s6, s7
    s_add_u32 s46, s34, s6
    s_addc_u32 s47, s35, 0
    s_add_u32 s50, s46, 2097152
    s_addc_u32 s51, s47, 0
    s_lshl_b32 s6, s65, 15
    s_lshl_b32 s7, s64, 9
    s_add_u32 s6, s6, s7
    s_add_u32 s6, s6, 1064960
PP_6:
    s_cbranch_execz L_dispatch
    v_lshlrev_b32 v28, 6, v3
    v_lshl_add_u32 v28, v8, 7, v28
    v_lshl_add_u32 v28, v1, 4, v28
    s_add_u32 s48, s34, s6
    s_addc_u32 s49, s35, 0
    s_mov_b32 s68, 0x3d372713
    s_mov_b32 s69, 0xc0135761
    s_mov_b32 s74, 16711935
    s_mov_b32 s75, 16711935
    s_mov_b32 s76, 1073692671
    s_mov_b32 s77, 0
    s_waitcnt lgkmcnt(0)
    s_add_u32 s82, s82, 1
    s_and_b32 s80, s82, 0xff
    s_mov_b32 s81, 0xffffff00
    v_mov_b32 v55, s80
    s_waitcnt vmcnt(0)
    v_cmp_eq_u32 vcc, 0, v8
    s_nop 1
    v_cndmask_b32 v128, 0, v16, vcc
    v_cndmask_b32 v129, 0, v17, vcc
    v_cndmask_b32 v130, 0, v18, vcc
    v_cndmask_b32 v131, 0, v19, vcc
    v_cndmask_b32 v132, 0, v20, vcc
    v_cndmask_b32 v133, 0, v21, vcc
    v_cndmask_b32 v134, 0, v22, vcc
    v_cndmask_b32 v135, 0, v23, vcc
    v_cndmask_b32 v12, v11, v10, vcc
    v_cmp_eq_u32 vcc, 1, v8
    s_nop 1
    v_cndmask_b32 v136, 0, v16, vcc
    v_cndmask_b32 v137, 0, v17, vcc
    v_cndmask_b32 v138, 0, v18, vcc
    v_cndmask_b32 v139, 0, v19, vcc
    v_cndmask_b32 v140, 0, v20, vcc
    v_cndmask_b32 v141, 0, v21, vcc
    v_cndmask_b32 v142, 0, v22, vcc
    v_cndmask_b32 v143, 0, v23, vcc
    v_cndmask_b32 v13, v11, v10, vcc
    v_cmp_eq_u32 vcc, 2, v8
    s_nop 1
    v_cndmask_b32 v144, 0, v16, vcc
    v_cndmask_b32 v145, 0, v17, vcc
    v_cndmask_b32 v146, 0, v18, vcc
    v_cndmask_b32 v147, 0, v19, vcc
    v_cndmask_b32 v148, 0, v20, vcc
    v_cndmask_b32 v149, 0, v21, vcc
    v_cndmask_b32 v150, 0, v22, vcc
    v_cndmask_b32 v151, 0, v23, vcc
    v_cndmask_b32 v14, v11, v10, vcc
    v_cmp_eq_u32 vcc, 3, v8
    s_nop 1
    v_cndmask_b32 v152, 0, v16, vcc
    v_cndmask_b32 v153, 0, v17, vcc
    v_cndmask_b32 v154, 0, v18, vcc
    v_cndmask_b32 v155, 0, v19, vcc
    v_cndmask_b32 v156, 0, v20, vcc
    v_cndmask_b32 v157, 0, v21, vcc
    v_cndmask_b32 v158, 0, v22, vcc
    v_cndmask_b32 v159, 0, v23, vcc
    v_cndmask_b32 v15, v11, v10, vcc
    v_lshlrev_b32 v20, 16, v24
    v_and_b32 v21, 0xffff0000, v24
    v_lshlrev_b32 v22, 16, v25
    v_and_b32 v23, 0xffff0000, v25
    s_cmp_ge_u32 s79, 44
    s_cbranch_scc1 Ls_64
Lp_63:
    s_sleep 1
    s_sub_u32 s83, s83, 1
    s_cbranch_scc1 L_end
    ds_read_b32 v56, v54 offset:0
    s_waitcnt lgkmcnt(0)
    v_readfirstlane_b32 s79, v56
    s_cmp_lt_u32 s79, 44
    s_cbranch_scc1 Lp_63
Ls_64:
    ds_read_b64_tr_b16 v[64:65], v48 offset:49152
    ds_read_b64_tr_b16 v[66:67], v48 offset:49664
    ds_read_b64_tr_b16 v[68:69], v49 offset:49152
    ds_read_b64_tr_b16 v[70:71], v49 offset:49664
    ds_read_b64_tr_b16 v[72:73], v50 offset:49152
    ds_read_b64_tr_b16 v[74:75], v50 offset:49664
    ds_read_b64_tr_b16 v[76:77], v51 offset:49152
    ds_read_b64_tr_b16 v[78:79], v51 offset:49664
    ds_read_b64_tr_b16 v[80:81], v48 offset:53248
    ds_read_b64_tr_b16 v[82:83], v48 offset:53760
    ds_read_b64_tr_b16 v[84:85], v49 offset:53248
    ds_read_b64_tr_b16 v[86:87], v49 offset:53760
    ds_read_b64_tr_b16 v[88:89], v50 offset:53248
    ds_read_b64_tr_b16 v[90:91], v50 offset:53760
    ds_read_b64_tr_b16 v[92:93], v51 offset:53248
    ds_read_b64_tr_b16 v[94:95], v51 offset:53760
    s_waitcnt lgkmcnt(8)
    v_mfma_f32_16x16x32_bf16 v[96:99], v[64:67], v[128:131], 0
    v_mfma_f32_16x16x32_bf16 v[96:99], v[68:71], v[136:139], v[96:99]
    v_mfma_f32_16x16x32_bf16 v[96:99], v[72:75], v[144:147], v[96:99]
    v_mfma_f32_16x16x32_bf16 v[96:99], v[76:79], v[152:155], v[96:99]
    s_waitcnt lgkmcnt(0)
    v_mfma_f32_16x16x32_bf16 v[96:99], v[80:83], v[132:135], v[96:99]
    v_mfma_f32_16x16x32_bf16 v[96:99], v[84:87], v[140:143], v[96:99]
    v_mfma_f32_16x16x32_bf16 v[96:99], v[88:91], v[148:151], v[96:99]
    v_mfma_f32_16x16x32_bf16 v[96:99], v[92:95], v[156:159], v[96:99]
    s_mov_b64 exec, s[74:75]
    s_nop 6
    v_add_u32 v96, 0x80, v96
    v_add_u32 v97, 0x80, v97
    v_add_u32 v98, 0x80, v98
    v_add_u32 v99, 0x80, v99
    v_and_or_b32 v96, v96, s81, v55
    v_and_or_b32 v97, v97, s81, v55
    v_and_or_b32 v98, v98, s81, v55
    v_and_or_b32 v99, v99, s81, v55
    global_store_dwordx4 v52, v[96:99], s[46:47]
    global_store_dwordx4 v52, v[96:99], s[50:51] sc1
    s_mov_b64 exec, -1
    s_cmp_ge_u32 s79, 68
    s_cbranch_scc1 Ls_66
Lp_65:
    s_sleep 4
    s_sub_u32 s83, s83, 1
    s_cbranch_scc1 L_end
    ds_read_b32 v56, v54 offset:0
    s_waitcnt lgkmcnt(0)
    v_readfirstlane_b32 s79, v56
    s_cmp_lt_u32 s79, 68
    s_cbranch_scc1 Lp_65
Ls_66:
    s_mov_b64 exec, s[76:77]
    s_mov_b32 s78, 64
Lh_67:
    s_sub_u32 s83, s83, 1
    s_cbranch_scc1 L_end
    s_sub_u32 s78, s78, 1
    s_cbranch_scc0 Lb_68
    s_add_u32 s44, s44, 2097152
    s_addc_u32 s45, s45, 0
    s_mov_b32 s78, 0x7fffffff
Lb_68:
    global_load_dwordx4 v[160:163], v53, s[44:45] offset:0 sc1
    global_load_dwordx4 v[164:167], v53, s[44:45] offset:256 sc1
    global_load_dwordx4 v[168:171], v53, s[44:45] offset:512 sc1
    global_load_dwordx4 v[172:175], v53, s[44:45] offset:768 sc1
    global_load_dwordx4 v[176:179], v53, s[44:45] offset:1024 sc1
    global_load_dwordx4 v[180:183], v53, s[44:45] offset:1280 sc1
    global_load_dwordx4 v[184:187], v53, s[44:45] offset:1536 sc1
    global_load_dwordx4 v[188:191], v53, s[44:45] offset:1792 sc1
    s_waitcnt vmcnt(0)
    v_xor_b32 v160, s80, v160
    v_xor_b32 v161, s80, v161
    v_xor_b32 v162, s80, v162
    v_xor_b32 v163, s80, v163
    v_xor_b32 v164, s80, v164
    v_xor_b32 v165, s80, v165
    v_xor_b32 v166, s80, v166
    v_xor_b32 v167, s80, v167
    v_xor_b32 v168, s80, v168
    v_xor_b32 v169, s80, v169
    v_xor_b32 v170, s80, v170
    v_xor_b32 v171, s80, v171
    v_xor_b32 v172, s80, v172
    v_xor_b32 v173, s80, v173
    v_xor_b32 v174, s80, v174
    v_xor_b32 v175, s80, v175
    v_xor_b32 v176, s80, v176
    v_xor_b32 v177, s80, v177
    v_xor_b32 v178, s80, v178
    v_xor_b32 v179, s80, v179
    v_xor_b32 v180, s80, v180
    v_xor_b32 v181, s80, v181
    v_xor_b32 v182, s80, v182
    v_xor_b32 v183, s80, v183
    v_xor_b32 v184, s80, v184
    v_xor_b32 v185, s80, v185
    v_xor_b32 v186, s80, v186
    v_xor_b32 v187, s80, v187
    v_xor_b32 v188, s80, v188
    v_xor_b32 v189, s80, v189
    v_xor_b32 v190, s80, v190
    v_xor_b32 v191, s80, v191
    v_or3_b32 v56, v160, v161, v162
    v_or3_b32 v56, v56, v163, v164
    v_or3_b32 v56, v56, v165, v166
    v_or3_b32 v56, v56, v167, v168
    v_or3_b32 v56, v56, v169, v170
    v_or3_b32 v56, v56, v171, v172
    v_or3_b32 v56, v56, v173, v174
    v_or3_b32 v56, v56, v175, v176
    v_or3_b32 v56, v56, v177, v178
    v_or3_b32 v56, v56, v179, v180
    v_or3_b32 v56, v56, v181, v182
    v_or3_b32 v56, v56, v183, v184
    v_or3_b32 v56, v56, v185, v186
    v_or3_b32 v56, v56, v187, v188
    v_or3_b32 v56, v56, v189, v190
    v_or_b32 v56, v56, v191
    v_and_b32 v56, 0xff, v56
    v_cmp_ne_u32 vcc, 0, v56
    s_cbranch_vccnz Lh_67
    v_add_f32 v160, v160, v176
    v_add_f32 v161, v161, v177
PP_7:
    s_cbranch_execz L_dispatch
    v_add_f32 v162, v162, v178
    v_add_f32 v163, v163, v179
    v_add_f32 v164, v164, v180
    v_add_f32 v165, v165, v181
    v_add_f32 v166, v166, v182
    v_add_f32 v167, v167, v183
    v_add_f32 v168, v168, v184
    v_add_f32 v169, v169, v185
    v_add_f32 v170, v170, v186
    v_add_f32 v171, v171, v187
    v_add_f32 v172, v172, v188
    v_add_f32 v173, v173, v189
    v_add_f32 v174, v174, v190
    v_add_f32 v175, v175, v191
    v_add_f32 v160, v160, v168
    v_add_f32 v161, v161, v169
    v_add_f32 v162, v162, v170
    v_add_f32 v163, v163, v171
    v_add_f32 v164, v164, v172
    v_add_f32 v165, v165, v173
    v_add_f32 v166, v166, v174
    v_add_f32 v167, v167, v175
    v_add_f32 v32, v160, v164
    v_add_f32 v33, v161, v165
    v_add_f32 v34, v162, v166
    v_add_f32 v35, v163, v167
    v_cvt_pk_bf16_f32 v36, v32, v33
    v_cvt_pk_bf16_f32 v37, v34, v35
    v_lshlrev_b32 v32, 16, v36
    v_and_b32 v33, 0xffff0000, v36
    v_lshlrev_b32 v34, 16, v37
    v_and_b32 v35, 0xffff0000, v37
    v_add_f32 v32, v32, v20
    v_add_f32 v33, v33, v21
    v_add_f32 v34, v34, v22
    v_add_f32 v35, v35, v23
    v_cvt_pk_bf16_f32 v36, v32, v33
    v_cvt_pk_bf16_f32 v37, v34, v35
    v_lshlrev_b32 v32, 16, v36
    v_and_b32 v33, 0xffff0000, v36
    v_lshlrev_b32 v34, 16, v37
    v_and_b32 v35, 0xffff0000, v37
    v_mul_f32 v40, v32, v32
    v_mul_f32 v41, v33, v33
    v_mul_f32 v42, v34, v34
    v_mul_f32 v43, v35, v35
    v_fma_f32 v40, v40, s68, 1.0
    v_fma_f32 v41, v41, s68, 1.0
    v_fma_f32 v42, v42, s68, 1.0
    v_fma_f32 v43, v43, s68, 1.0
    v_mul_f32 v40, v40, v32
    v_mul_f32 v41, v41, v33
    v_mul_f32 v42, v42, v34
    v_mul_f32 v43, v43, v35
    v_mul_f32 v40, s69, v40
    v_mul_f32 v41, s69, v41
    v_mul_f32 v42, s69, v42
    v_mul_f32 v43, s69, v43
    v_exp_f32 v40, v40
    v_exp_f32 v41, v41
    v_exp_f32 v42, v42
    v_exp_f32 v43, v43
    v_add_f32 v40, 1.0, v40
    v_add_f32 v41, 1.0, v41
    v_add_f32 v42, 1.0, v42
    v_add_f32 v43, 1.0, v43
    v_rcp_f32 v40, v40
    v_rcp_f32 v41, v41
    v_rcp_f32 v42, v42
    v_rcp_f32 v43, v43
    v_mul_f32 v32, v32, v40
    v_mul_f32 v33, v33, v41
    v_mul_f32 v34, v34, v42
    v_mul_f32 v35, v35, v43
    v_cvt_pk_bf16_f32 v26, v32, v33
    v_cvt_pk_bf16_f32 v27, v34, v35
    s_mov_b32 exec_lo, -1
    ds_write_b64 v9, v[26:27]
    s_mov_b64 exec, -1
    ds_read_b128 v[192:195], v12 offset:0
    ds_read_b128 v[196:199], v12 offset:64
    ds_read_b128 v[200:203], v13 offset:0
    ds_read_b128 v[204:207], v13 offset:64
    ds_read_b128 v[208:211], v14 offset:0
    ds_read_b128 v[212:215], v14 offset:64
    ds_read_b128 v[216:219], v15 offset:0
    ds_read_b128 v[220:223], v15 offset:64
    s_cmp_ge_u32 s79, 116
    s_cbranch_scc1 Ls_70
Lp_69:
    s_sub_u32 s83, s83, 1
    s_cbranch_scc1 L_end
    ds_read_b32 v56, v54 offset:0
    s_waitcnt lgkmcnt(0)
    v_readfirstlane_b32 s79, v56
    s_cmp_lt_u32 s79, 116
    s_cbranch_scc1 Lp_69
Ls_70:
    ds_read_b64_tr_b16 v[64:65], v44 offset:0
    ds_read_b64_tr_b16 v[66:67], v44 offset:512
    ds_read_b64_tr_b16 v[68:69], v45 offset:0
    ds_read_b64_tr_b16 v[70:71], v45 offset:512
    ds_read_b64_tr_b16 v[72:73], v46 offset:0
    ds_read_b64_tr_b16 v[74:75], v46 offset:512
    ds_read_b64_tr_b16 v[76:77], v47 offset:0
    ds_read_b64_tr_b16 v[78:79], v47 offset:512
    ds_read_b64_tr_b16 v[80:81], v44 offset:4096
    ds_read_b64_tr_b16 v[82:83], v44 offset:4608
    ds_read_b64_tr_b16 v[84:85], v45 offset:4096
    ds_read_b64_tr_b16 v[86:87], v45 offset:4608
    ds_read_b64_tr_b16 v[88:89], v46 offset:4096
    ds_read_b64_tr_b16 v[90:91], v46 offset:4608
    ds_read_b64_tr_b16 v[92:93], v47 offset:4096
    ds_read_b64_tr_b16 v[94:95], v47 offset:4608
    s_waitcnt lgkmcnt(8)
    v_mfma_f32_16x16x32_bf16 v[100:103], v[64:67], v[192:195], 0
    v_mfma_f32_16x16x32_bf16 v[100:103], v[68:71], v[200:203], v[100:103]
    v_mfma_f32_16x16x32_bf16 v[100:103], v[72:75], v[208:211], v[100:103]
    v_mfma_f32_16x16x32_bf16 v[100:103], v[76:79], v[216:219], v[100:103]
    s_waitcnt lgkmcnt(0)
    v_mfma_f32_16x16x32_bf16 v[100:103], v[80:83], v[196:199], v[100:103]
    v_mfma_f32_16x16x32_bf16 v[100:103], v[84:87], v[204:207], v[100:103]
    v_mfma_f32_16x16x32_bf16 v[100:103], v[88:91], v[212:215], v[100:103]
    v_mfma_f32_16x16x32_bf16 v[100:103], v[92:95], v[220:223], v[100:103]
    s_mov_b64 exec, s[74:75]
    s_nop 6
    v_and_or_b32 v100, v100, s81, v55
    v_and_or_b32 v101, v101, s81, v55
    v_and_or_b32 v102, v102, s81, v55
    v_and_or_b32 v103, v103, s81, v55
    global_store_dwordx4 v28, v[100:103], s[48:49] sc1
    s_mov_b64 exec, -1
    s_cmp_lg_u32 s63, 0
    s_cbranch_scc1 L_ffn_end
    s_lshl_b32 s6, s4, 15
    s_lshr_b32 s7, s5, 3
    s_lshl_b32 s71, s7, 7
    s_add_u32 s6, s6, s71
    s_add_u32 s6, s6, 1064960
    v_lshrrev_b32 v62, 3, v0
    v_lshlrev_b32 v62, 9, v62
    v_and_b32 v58, 7, v0
    v_lshl_add_u32 v62, v58, 4, v62
    v_add_u32 v57, 0x2000, v62
    s_lshl_b32 s71, s4, 7
    s_lshl_b32 s7, s7, 5
    s_add_u32 s71, s71, s7
    v_and_b32 v63, 3, v0
    v_lshlrev_b32 v63, 3, v63
    v_lshl_add_u32 v63, v1, 1, v63
    v_add_u32 v63, s71, v63
    s_add_u32 s50, s34, s6
    s_addc_u32 s51, s35, 0
    s_add_u32 s50, s50, 4096
    s_addc_u32 s51, s51, 0
    global_load_ushort v61, v63, s[26:27]
Lw_71:
    s_sleep 1
    s_sub_u32 s83, s83, 1
    s_cbranch_scc1 L_end
    ds_read_b32 v56, v54 offset:12
    s_waitcnt lgkmcnt(0)
    v_cmp_gt_u32 vcc, 1, v56
    s_cbranch_vccnz Lw_71
Lg_72:
    s_sub_u32 s83, s83, 1
    s_cbranch_scc1 L_end
    global_load_dwordx4 v[64:67], v62, s[50:51] offset:-4096 sc1
    global_load_dwordx4 v[68:71], v62, s[50:51] offset:0 sc1
    global_load_dwordx4 v[72:75], v57, s[50:51] offset:-4096 sc1
    global_load_dwordx4 v[76:79], v57, s[50:51] offset:0 sc1
    s_waitcnt vmcnt(3)
    v_xor_b32 v64, s80, v64
    v_xor_b32 v65, s80, v65
    v_xor_b32 v66, s80, v66
    v_xor_b32 v67, s80, v67
    v_or3_b32 v56, v64, v65, v66
    v_or_b32 v56, v56, v67
    s_waitcnt vmcnt(2)
    v_xor_b32 v68, s80, v68
    v_xor_b32 v69, s80, v69
    v_xor_b32 v70, s80, v70
    v_xor_b32 v71, s80, v71
    v_or3_b32 v56, v56, v68, v69
    v_or3_b32 v56, v56, v70, v71
    v_add_f32 v64, v64, v68
    v_add_f32 v65, v65, v69
    v_add_f32 v66, v66, v70
    v_add_f32 v67, v67, v71
    s_waitcnt vmcnt(1)
    v_xor_b32 v72, s80, v72
    v_xor_b32 v73, s80, v73
    v_xor_b32 v74, s80, v74
    v_xor_b32 v75, s80, v75
    v_or3_b32 v56, v56, v72, v73
    v_or3_b32 v56, v56, v74, v75
    v_add_f32 v64, v64, v72
    v_add_f32 v65, v65, v73
    v_add_f32 v66, v66, v74
    v_add_f32 v67, v67, v75
    s_waitcnt vmcnt(0)
    v_xor_b32 v76, s80, v76
    v_xor_b32 v77, s80, v77
    v_xor_b32 v78, s80, v78
PP_8:
    s_cbranch_execz L_dispatch
    v_xor_b32 v79, s80, v79
    v_or3_b32 v56, v56, v76, v77
    v_or3_b32 v56, v56, v78, v79
    v_add_f32 v64, v64, v76
    v_add_f32 v65, v65, v77
    v_add_f32 v66, v66, v78
    v_add_f32 v67, v67, v79
    v_and_b32 v56, 0xff, v56
    v_cmp_ne_u32 vcc, 0, v56
    s_cbranch_vccnz Lg_72
    v_permlane32_swap_b32 v64, v66
    v_permlane32_swap_b32 v65, v67
    v_add_f32 v64, v64, v66
    v_add_f32 v65, v65, v67
    s_nop 1
    v_permlane16_swap_b32 v64, v65
    v_add_f32 v64, v64, v65
    s_nop 1
    v_add_f32_dpp v64, v64, v64 row_ror:8 row_mask:0xf bank_mask:0xf
    v_lshlrev_b32 v61, 16, v61
    v_cvt_pk_bf16_f32 v64, v64, v64
    v_and_b32 v64, 0xffff0000, v64
    v_add_f32 v64, v64, v61
    v_cvt_pk_bf16_f32 v64, v64, v64
    v_and_b32 v64, 0xffff0000, v64
    v_lshlrev_b32 v60, 2, v0
    v_add_u32 v60, 121088, v60
    v_mov_b32 v59, 1
    ds_write_b32 v60, v64
    ds_write_b32 v54, v59 offset:24
    s_cmp_lg_u32 s2, 0
    s_cbranch_scc1 L_ffn_end
    s_mov_b32 exec_hi, 0
    v_mov_b32 v72, s82
    v_lshlrev_b32 v73, 2, v0
    global_store_dword v73, v72, s[34:35]
L_ffn_end:
    s_endpgm
L_aux:
    s_setprio 3
    s_cmp_lg_u32 s63, 0
    s_cbranch_scc1 L_end
    v_mov_b32 v54, 117504
    v_lshlrev_b32 v53, 2, v0
    v_add_u32 v60, 121088, v53
    s_waitcnt lgkmcnt(0)
    s_add_u32 s82, s82, 1
    s_and_b32 s80, s82, 0xff
    s_mov_b32 s81, 0xffffff00
    s_lshl_b32 s6, s4, 15
    s_lshr_b32 s7, s5, 3
    s_lshl_b32 s71, s7, 7
    s_add_u32 s6, s6, s71
    s_add_u32 s6, s6, 1048576
    v_lshrrev_b32 v62, 3, v0
    v_lshlrev_b32 v62, 9, v62
    v_and_b32 v58, 7, v0
    v_lshl_add_u32 v62, v58, 4, v62
    v_add_u32 v57, 0x2000, v62
    s_lshl_b32 s71, s4, 7
    s_lshl_b32 s7, s7, 5
    s_add_u32 s71, s71, s7
    v_and_b32 v63, 3, v0
    v_lshlrev_b32 v63, 3, v63
    v_lshl_add_u32 v63, v1, 1, v63
    v_add_u32 v63, s71, v63
    s_add_u32 s50, s34, s6
    s_addc_u32 s51, s35, 0
    s_add_u32 s50, s50, 4096
    s_addc_u32 s51, s51, 0
    v_lshlrev_b32 v4, 5, v0
    v_and_b32 v5, 31, v0
    v_lshlrev_b32 v5, 5, v5
    global_load_dwordx4 v[32:35], v4, s[8:9]
    global_load_dwordx4 v[36:39], v4, s[8:9] offset:16
    global_load_dwordx4 v[40:43], v5, s[28:29]
    global_load_dwordx4 v[44:47], v5, s[28:29] offset:16
    global_load_dwordx4 v[64:67], v62, s[50:51] offset:-4096 sc1
    global_load_dwordx4 v[68:71], v62, s[50:51] offset:0 sc1
    global_load_dwordx4 v[72:75], v57, s[50:51] offset:-4096 sc1
    global_load_dwordx4 v[76:79], v57, s[50:51] offset:0 sc1
    s_waitcnt vmcnt(4)
    v_lshlrev_b32 v6, 16, v32
    v_and_b32 v7, 0xffff0000, v32
    v_lshlrev_b32 v8, 16, v40
    v_and_b32 v9, 0xffff0000, v40
    v_mul_f32 v6, v6, v8
    v_mul_f32 v7, v7, v9
    v_cvt_pk_bf16_f32 v6, v6, v7
    v_lshlrev_b32 v7, 16, v6
    v_and_b32 v6, 0xffff0000, v6
    v_add_f32 v7, v7, v6
    v_mov_b32 v10, v7
    v_lshlrev_b32 v6, 16, v33
    v_and_b32 v7, 0xffff0000, v33
    v_lshlrev_b32 v8, 16, v41
    v_and_b32 v9, 0xffff0000, v41
    v_mul_f32 v6, v6, v8
    v_mul_f32 v7, v7, v9
    v_cvt_pk_bf16_f32 v6, v6, v7
    v_lshlrev_b32 v7, 16, v6
    v_and_b32 v6, 0xffff0000, v6
    v_add_f32 v7, v7, v6
    v_add_f32 v10, v10, v7
    v_lshlrev_b32 v6, 16, v34
    v_and_b32 v7, 0xffff0000, v34
    v_lshlrev_b32 v8, 16, v42
    v_and_b32 v9, 0xffff0000, v42
    v_mul_f32 v6, v6, v8
    v_mul_f32 v7, v7, v9
    v_cvt_pk_bf16_f32 v6, v6, v7
    v_lshlrev_b32 v7, 16, v6
    v_and_b32 v6, 0xffff0000, v6
    v_add_f32 v7, v7, v6
    v_add_f32 v10, v10, v7
    v_lshlrev_b32 v6, 16, v35
    v_and_b32 v7, 0xffff0000, v35
    v_lshlrev_b32 v8, 16, v43
    v_and_b32 v9, 0xffff0000, v43
    v_mul_f32 v6, v6, v8
    v_mul_f32 v7, v7, v9
    v_cvt_pk_bf16_f32 v6, v6, v7
    v_lshlrev_b32 v7, 16, v6
    v_and_b32 v6, 0xffff0000, v6
    v_add_f32 v7, v7, v6
    v_add_f32 v10, v10, v7
    v_lshlrev_b32 v6, 16, v36
    v_and_b32 v7, 0xffff0000, v36
    v_lshlrev_b32 v8, 16, v44
    v_and_b32 v9, 0xffff0000, v44
    v_mul_f32 v6, v6, v8
    v_mul_f32 v7, v7, v9
    v_cvt_pk_bf16_f32 v6, v6, v7
    v_lshlrev_b32 v7, 16, v6
    v_and_b32 v6, 0xffff0000, v6
    v_add_f32 v7, v7, v6
    v_add_f32 v10, v10, v7
    v_lshlrev_b32 v6, 16, v37
    v_and_b32 v7, 0xffff0000, v37
    v_lshlrev_b32 v8, 16, v45
    v_and_b32 v9, 0xffff0000, v45
    v_mul_f32 v6, v6, v8
    v_mul_f32 v7, v7, v9
    v_cvt_pk_bf16_f32 v6, v6, v7
    v_lshlrev_b32 v7, 16, v6
    v_and_b32 v6, 0xffff0000, v6
    v_add_f32 v7, v7, v6
    v_add_f32 v10, v10, v7
    v_lshlrev_b32 v6, 16, v38
    v_and_b32 v7, 0xffff0000, v38
    v_lshlrev_b32 v8, 16, v46
    v_and_b32 v9, 0xffff0000, v46
    v_mul_f32 v6, v6, v8
    v_mul_f32 v7, v7, v9
    v_cvt_pk_bf16_f32 v6, v6, v7
    v_lshlrev_b32 v7, 16, v6
    v_and_b32 v6, 0xffff0000, v6
    v_add_f32 v7, v7, v6
    v_add_f32 v10, v10, v7
    v_lshlrev_b32 v6, 16, v39
    v_and_b32 v7, 0xffff0000, v39
    v_lshlrev_b32 v8, 16, v47
    v_and_b32 v9, 0xffff0000, v47
    v_mul_f32 v6, v6, v8
    v_mul_f32 v7, v7, v9
    v_cvt_pk_bf16_f32 v6, v6, v7
    v_lshlrev_b32 v7, 16, v6
    v_and_b32 v6, 0xffff0000, v6
    v_add_f32 v7, v7, v6
    v_add_f32 v10, v10, v7
    s_nop 1
    v_add_f32_dpp v10, v10, v10 row_ror:1 row_mask:0xf bank_mask:0xf
    s_nop 1
    v_add_f32_dpp v10, v10, v10 row_ror:2 row_mask:0xf bank_mask:0xf
    s_nop 1
    v_add_f32_dpp v10, v10, v10 row_ror:4 row_mask:0xf bank_mask:0xf
    s_nop 1
    v_add_f32_dpp v10, v10, v10 row_ror:8 row_mask:0xf bank_mask:0xf
    v_mov_b32 v11, v10
    s_nop 1
    v_permlane16_swap_b32 v10, v11
    v_add_f32 v10, v10, v11
    v_cvt_pk_bf16_f32 v10, v10, v10
    v_and_b32 v10, 0xffff0000, v10
    v_mul_f32 v10, 0xbfb8aa3b, v10
    v_exp_f32 v10, v10
    s_nop 0
    v_add_f32 v10, 1.0, v10
    v_rcp_f32 v10, v10
    s_nop 0
    v_cvt_pk_bf16_f32 v10, v10, v10
    v_and_b32 v10, 0xffff0000, v10
    v_mov_b32 v11, v10
    s_mov_b32 s76, 0xf0f0f0f0
    s_mov_b32 s77, 0xf0f0f0f0
    v_permlane32_swap_b32 v10, v11
    v_cndmask_b32 v10, v10, v11, s[76:77]
    v_sub_f32 v11, 1.0, v10
    v_cvt_pk_bf16_f32 v11, v11, v11
PP_9:
    s_cbranch_execz L_dispatch
    v_and_b32 v11, 0xffff0000, v11
    v_and_b32 v12, 4, v0
    v_lshl_add_u32 v63, v12, 8, v63
    s_mov_b32 s74, 0x00ff00ff
    s_mov_b32 s75, 0x00ff00ff
Lw_73:
    s_sleep 1
    s_sub_u32 s83, s83, 1
    s_cbranch_scc1 L_end
    ds_read_b32 v56, v54 offset:12
    s_waitcnt lgkmcnt(0)
    v_cmp_gt_u32 vcc, 4, v56
    s_cbranch_vccnz Lw_73
    global_load_dwordx4 v[96:99], v62, s[50:51] offset:-4096 sc1
    global_load_dwordx4 v[100:103], v62, s[50:51] offset:0 sc1
    global_load_dwordx4 v[104:107], v57, s[50:51] offset:-4096 sc1
    global_load_dwordx4 v[108:111], v57, s[50:51] offset:0 sc1
Lf_74:
    s_sub_u32 s83, s83, 1
    s_cbranch_scc1 L_end
    global_load_dwordx4 v[112:115], v62, s[50:51] offset:-4096 sc1
    global_load_dwordx4 v[116:119], v62, s[50:51] offset:0 sc1
    global_load_dwordx4 v[120:123], v57, s[50:51] offset:-4096 sc1
    global_load_dwordx4 v[124:127], v57, s[50:51] offset:0 sc1
    ds_read_b32 v56, v54 offset:24
    ds_read_b32 v13, v60
    s_waitcnt lgkmcnt(0)
    v_xor_b32 v56, 1, v56
    v_mul_f32 v13, v13, v11
    v_cvt_pk_bf16_f32 v13, v13, v13
    v_and_b32 v13, 0xffff0000, v13
    s_waitcnt vmcnt(7)
    v_xor_b32 v96, s80, v96
    v_xor_b32 v97, s80, v97
    v_xor_b32 v98, s80, v98
    v_xor_b32 v99, s80, v99
    v_or3_b32 v56, v56, v96, v97
    v_or3_b32 v56, v56, v98, v99
    s_waitcnt vmcnt(6)
    v_xor_b32 v100, s80, v100
    v_xor_b32 v101, s80, v101
    v_xor_b32 v102, s80, v102
    v_xor_b32 v103, s80, v103
    v_or3_b32 v56, v56, v100, v101
    v_or3_b32 v56, v56, v102, v103
    v_add_f32 v64, v96, v100
    v_add_f32 v65, v97, v101
    v_add_f32 v66, v98, v102
    v_add_f32 v67, v99, v103
    s_waitcnt vmcnt(5)
    v_xor_b32 v104, s80, v104
    v_xor_b32 v105, s80, v105
    v_xor_b32 v106, s80, v106
    v_xor_b32 v107, s80, v107
    v_or3_b32 v56, v56, v104, v105
    v_or3_b32 v56, v56, v106, v107
    v_add_f32 v64, v64, v104
    v_add_f32 v65, v65, v105
    v_add_f32 v66, v66, v106
    v_add_f32 v67, v67, v107
    s_waitcnt vmcnt(4)
    v_xor_b32 v108, s80, v108
    v_xor_b32 v109, s80, v109
    v_xor_b32 v110, s80, v110
    v_xor_b32 v111, s80, v111
    v_or3_b32 v56, v56, v108, v109
    v_or3_b32 v56, v56, v110, v111
    v_add_f32 v64, v64, v108
    v_add_f32 v65, v65, v109
    v_add_f32 v66, v66, v110
    v_add_f32 v67, v67, v111
    v_and_b32 v56, 0xff, v56
    v_cmp_ne_u32 vcc, 0, v56
    s_cbranch_vccz Lf_75
    global_load_dwordx4 v[96:99], v62, s[50:51] offset:-4096 sc1
    global_load_dwordx4 v[100:103], v62, s[50:51] offset:0 sc1
    global_load_dwordx4 v[104:107], v57, s[50:51] offset:-4096 sc1
    global_load_dwordx4 v[108:111], v57, s[50:51] offset:0 sc1
    ds_read_b32 v56, v54 offset:24
    ds_read_b32 v13, v60
    s_waitcnt lgkmcnt(0)
    v_xor_b32 v56, 1, v56
    v_mul_f32 v13, v13, v11
    v_cvt_pk_bf16_f32 v13, v13, v13
    v_and_b32 v13, 0xffff0000, v13
    s_waitcnt vmcnt(7)
    v_xor_b32 v112, s80, v112
    v_xor_b32 v113, s80, v113
    v_xor_b32 v114, s80, v114
    v_xor_b32 v115, s80, v115
    v_or3_b32 v56, v56, v112, v113
    v_or3_b32 v56, v56, v114, v115
    s_waitcnt vmcnt(6)
    v_xor_b32 v116, s80, v116
    v_xor_b32 v117, s80, v117
    v_xor_b32 v118, s80, v118
    v_xor_b32 v119, s80, v119
    v_or3_b32 v56, v56, v116, v117
    v_or3_b32 v56, v56, v118, v119
    v_add_f32 v64, v112, v116
    v_add_f32 v65, v113, v117
    v_add_f32 v66, v114, v118
    v_add_f32 v67, v115, v119
    s_waitcnt vmcnt(5)
    v_xor_b32 v120, s80, v120
    v_xor_b32 v121, s80, v121
    v_xor_b32 v122, s80, v122
    v_xor_b32 v123, s80, v123
    v_or3_b32 v56, v56, v120, v121
    v_or3_b32 v56, v56, v122, v123
    v_add_f32 v64, v64, v120
    v_add_f32 v65, v65, v121
    v_add_f32 v66, v66, v122
    v_add_f32 v67, v67, v123
    s_waitcnt vmcnt(4)
    v_xor_b32 v124, s80, v124
    v_xor_b32 v125, s80, v125
    v_xor_b32 v126, s80, v126
    v_xor_b32 v127, s80, v127
    v_or3_b32 v56, v56, v124, v125
    v_or3_b32 v56, v56, v126, v127
    v_add_f32 v64, v64, v124
    v_add_f32 v65, v65, v125
    v_add_f32 v66, v66, v126
    v_add_f32 v67, v67, v127
    v_and_b32 v56, 0xff, v56
    v_cmp_ne_u32 vcc, 0, v56
    s_cbranch_vccz Lf_75
    s_branch Lf_74
Lf_75:
    v_permlane32_swap_b32 v64, v66
    v_permlane32_swap_b32 v65, v67
    v_add_f32 v64, v64, v66
    v_add_f32 v65, v65, v67
    s_nop 1
    v_permlane16_swap_b32 v64, v65
    v_add_f32 v64, v64, v65
    s_nop 1
    v_add_f32_dpp v64, v64, v64 row_ror:8 row_mask:0xf bank_mask:0xf
    v_cvt_pk_bf16_f32 v64, v64, v64
    v_and_b32 v64, 0xffff0000, v64
    v_mul_f32 v64, v64, v10
    v_cvt_pk_bf16_f32 v64, v64, v64
    v_and_b32 v64, 0xffff0000, v64
    v_add_f32 v64, v64, v13
    v_cvt_pk_bf16_f32 v64, v64, v64
    s_mov_b64 exec, s[74:75]
    global_store_short v63, v64, s[30:31]
L_fin2:
L_end:
    s_endpgm
L_codeend:
.section .rodata,"a"
.p2align 6
.amdhsa_kernel gated_mix__sliding_block_cached__dense_activation_gelu__decode_kernel
  .amdhsa_next_free_vgpr 256
  .amdhsa_next_free_sgpr 102
  .amdhsa_accum_offset 256
  .amdhsa_group_segment_fixed_size 0
  .amdhsa_kernarg_size 112
  .amdhsa_user_sgpr_count 2
  .amdhsa_user_sgpr_kernarg_segment_ptr 1
  .amdhsa_system_sgpr_workgroup_id_x 1
.end_amdhsa_kernel
```
